```python
import torch

def _softmax(x, axis=-1):
    return torch.softmax(x, dim=axis)
def _gelu(x):
    return torch.nn.functional.gelu(x, approximate="tanh")
def _silu(x):
    return torch.nn.functional.silu(x)
def _sigmoid(x):
    return torch.sigmoid(x)
def _layernorm(x, axis=-1, eps=1e-5):
    m = x.mean(dim=axis, keepdim=True)
    v = x.var(dim=axis, keepdim=True, unbiased=False)
    return (x - m) / torch.sqrt(v + eps)
def _scatter_add(tgt, idx, src, axis=0):
    return tgt.clone().index_add_(axis, idx, src)
def _segment_sum(src, seg, n):
    out = torch.zeros((n,) + src.shape[1:], dtype=src.dtype)
    return out.index_add_(0, seg, src)
def _pad(x, pw):
    flat = tuple(v for pair in reversed(pw) for v in pair)
    return torch.nn.functional.pad(x, flat)

kernel_name = 'gather_scatter__cheap_equivariant_egnn__graph'

def setup_inputs():

    _w = (lambda a: (lambda t: t.to(torch.bfloat16) if t.is_floating_point() else t)(torch.as_tensor(a)))
    N, deg, D, De = 10000, 64, 64, max(16, 1)
    E = N * deg
    return {
        "h": _w((lambda *s: torch.randn(*s, dtype=torch.bfloat16) * 0.1)(N, D)),
        "pos": _w((lambda *s: torch.randn(*s, dtype=torch.bfloat16) * 0.8)(N, 3)),
        "e_attr": _w((lambda *s: torch.randn(*s, dtype=torch.bfloat16) * 0.8)(E, De)),
        "src": _w((lambda lo, hi, *s: torch.randint(lo, hi, s))(0, N, E).to(torch.int64)),
        "dst": _w((lambda lo, hi, *s: torch.randint(lo, hi, s))(0, N, E).to(torch.int64)),
        "w_e": _w(0.1 * (lambda *s: torch.randn(*s, dtype=torch.bfloat16) * 0.8)(2 * D + 1 + De, D)),
        "w_x": _w(0.1 * (lambda *s: torch.randn(*s, dtype=torch.bfloat16) * 0.1)(D, 1)),
        "w_h": _w(0.1 * (lambda *s: torch.randn(*s, dtype=torch.bfloat16) * 0.1)(2 * D, D)),
    }

def reference(h, pos, e_attr, src, dst, w_e, w_x, w_h):
    N, D = h.shape[0], h.shape[1]
    diff = pos[dst] - pos[src]
    dist2 = torch.sum(diff * diff, axis=-1, keepdims=True)
    e_in = torch.concatenate([h[dst], h[src], dist2, e_attr], axis=-1)
    m_ij = _silu(e_in @ w_e)
    coord_scale = m_ij @ w_x
    pos_new = pos + _segment_sum(diff * coord_scale, dst, N)
    m_i = _segment_sum(m_ij, dst, N)
    h_new = h + _silu(torch.concatenate([h, m_i], axis=-1) @ w_h)
    return h_new, pos_new
```

```asm
; @launch kernel=egnn_k0_kernel grid=(157,1,1) block=(256,1,1) lds=0
; @launch kernel=egnn_k1_kernel grid=(64,1,1) block=(1024,1,1) lds=40960
; @launch kernel=egnn_k2_kernel grid=(125,1,1) block=(1024,1,1) lds=41024
; @launch kernel=egnn_k3_kernel grid=(512,1,1) block=(256,1,1) lds=0
; @launch kernel=egnn_k4_kernel grid=(157,1,1) block=(256,1,1) lds=0
.amdgcn_target "amdgcn-amd-amdhsa--gfx950"
.text
.globl egnn_k0_kernel
.p2align 8
.type egnn_k0_kernel,@function
egnn_k0_kernel:
    s_load_dwordx16 s[4:19], s[0:1], 0
    s_load_dwordx2 s[20:21], s[0:1], 64
    s_load_dwordx2 s[22:23], s[0:1], 80
    s_waitcnt lgkmcnt(0)
    s_cmp_ge_u32 s2, 157
    s_cbranch_scc1 K0_END
    s_mov_b32 s24, s6
    s_mov_b32 s25, s7
    s_mov_b32 s26, 60000
    s_mov_b32 s27, 0x00020000
    s_mov_b32 s28, s22
    s_mov_b32 s29, s23
    s_mov_b32 s30, 40000
    s_mov_b32 s31, 0x00020000
    s_add_u32 s32, s22, 0x790000
    s_addc_u32 s33, s23, 0
    s_mov_b32 s34, 160000
    s_mov_b32 s35, 0x00020000
    s_mov_b32 s36, s4
    s_mov_b32 s37, s5
    s_mov_b32 s38, 1280000
    s_mov_b32 s39, 0x00020000
    s_mov_b32 s40, s14
    s_mov_b32 s41, s15
    s_mov_b32 s42, 18560
    s_mov_b32 s43, 0x00020000
    s_add_u32 s44, s22, 0xa40000
    s_addc_u32 s45, s23, 0
    s_mov_b32 s46, 2560000
    s_mov_b32 s47, 0x00020000
    s_mov_b32 s48, s18
    s_mov_b32 s49, s19
    s_mov_b32 s50, 16384
    s_mov_b32 s51, 0x00020000
    s_add_u32 s52, s22, 0xcc0000
    s_addc_u32 s53, s23, 0
    s_mov_b32 s54, 12288
    s_mov_b32 s55, 0x00020000
    s_add_u32 s56, s22, 0xcc4000
    s_addc_u32 s57, s23, 0
    s_mov_b32 s58, 16384
    s_mov_b32 s59, 0x00020000
    v_lshlrev_b32 v1, 6, s2
    v_add_u32 v1, v1, v0
    v_cmp_gt_u32 vcc, 64, v0
    s_and_saveexec_b64 s[60:61], vcc
    s_cbranch_execz K0_A_DONE
    v_mul_u32_u24 v2, 6, v1
    buffer_load_ushort v4, v2, s[24:27], 0 offen
    buffer_load_ushort v5, v2, s[24:27], 0 offen offset:2
    buffer_load_ushort v6, v2, s[24:27], 0 offen offset:4
    v_mov_b32 v7, 0
    v_lshlrev_b32 v3, 2, v1
    buffer_store_dword v7, v3, s[28:31], 0 offen
    v_lshlrev_b32 v3, 4, v1
    s_waitcnt vmcnt(1)
    v_lshlrev_b32 v4, 16, v4
    v_lshlrev_b32 v5, 16, v5
    v_lshlrev_b32 v6, 16, v6
    buffer_store_dwordx4 v[4:7], v3, s[32:35], 0 offen
K0_A_DONE:
    s_mov_b64 exec, -1
    v_and_b32 v1, 63, v0
    v_lshrrev_b32 v2, 6, v0
    v_and_b32 v3, 15, v1
    v_lshrrev_b32 v4, 4, v1
    v_lshlrev_b32 v5, 10, v4
    v_lshl_add_u32 v5, v3, 1, v5
    v_add_u32 v72, 4096, v5
    buffer_load_ushort v48, v5, s[40:43], 0 offen offset:0
    buffer_load_ushort v49, v5, s[40:43], 0 offen offset:128
    buffer_load_ushort v50, v5, s[40:43], 0 offen offset:256
    buffer_load_ushort v51, v5, s[40:43], 0 offen offset:384
    buffer_load_ushort v52, v5, s[40:43], 0 offen offset:512
    buffer_load_ushort v53, v5, s[40:43], 0 offen offset:640
    buffer_load_ushort v54, v5, s[40:43], 0 offen offset:768
    buffer_load_ushort v55, v5, s[40:43], 0 offen offset:896
    s_waitcnt vmcnt(0)
    v_lshl_or_b32 v16, v49, 16, v48
    v_lshl_or_b32 v17, v51, 16, v50
    v_lshl_or_b32 v18, v53, 16, v52
    v_lshl_or_b32 v19, v55, 16, v54
    buffer_load_ushort v48, v5, s[40:43], 0 offen offset:32
    buffer_load_ushort v49, v5, s[40:43], 0 offen offset:160
    buffer_load_ushort v50, v5, s[40:43], 0 offen offset:288
    buffer_load_ushort v51, v5, s[40:43], 0 offen offset:416
    buffer_load_ushort v52, v5, s[40:43], 0 offen offset:544
    buffer_load_ushort v53, v5, s[40:43], 0 offen offset:672
    buffer_load_ushort v54, v5, s[40:43], 0 offen offset:800
    buffer_load_ushort v55, v5, s[40:43], 0 offen offset:928
    s_waitcnt vmcnt(0)
    v_lshl_or_b32 v20, v49, 16, v48
    v_lshl_or_b32 v21, v51, 16, v50
    v_lshl_or_b32 v22, v53, 16, v52
    v_lshl_or_b32 v23, v55, 16, v54
    buffer_load_ushort v48, v5, s[40:43], 0 offen offset:64
    buffer_load_ushort v49, v5, s[40:43], 0 offen offset:192
    buffer_load_ushort v50, v5, s[40:43], 0 offen offset:320
    buffer_load_ushort v51, v5, s[40:43], 0 offen offset:448
    buffer_load_ushort v52, v5, s[40:43], 0 offen offset:576
    buffer_load_ushort v53, v5, s[40:43], 0 offen offset:704
    buffer_load_ushort v54, v5, s[40:43], 0 offen offset:832
    buffer_load_ushort v55, v5, s[40:43], 0 offen offset:960
    s_waitcnt vmcnt(0)
    v_lshl_or_b32 v24, v49, 16, v48
    v_lshl_or_b32 v25, v51, 16, v50
    v_lshl_or_b32 v26, v53, 16, v52
    v_lshl_or_b32 v27, v55, 16, v54
    buffer_load_ushort v48, v5, s[40:43], 0 offen offset:96
    buffer_load_ushort v49, v5, s[40:43], 0 offen offset:224
    buffer_load_ushort v50, v5, s[40:43], 0 offen offset:352
    buffer_load_ushort v51, v5, s[40:43], 0 offen offset:480
    buffer_load_ushort v52, v5, s[40:43], 0 offen offset:608
    buffer_load_ushort v53, v5, s[40:43], 0 offen offset:736
    buffer_load_ushort v54, v5, s[40:43], 0 offen offset:864
    buffer_load_ushort v55, v5, s[40:43], 0 offen offset:992
    s_waitcnt vmcnt(0)
    v_lshl_or_b32 v28, v49, 16, v48
    v_lshl_or_b32 v29, v51, 16, v50
    v_lshl_or_b32 v30, v53, 16, v52
    v_lshl_or_b32 v31, v55, 16, v54
    buffer_load_ushort v48, v72, s[40:43], 0 offen offset:0
    buffer_load_ushort v49, v72, s[40:43], 0 offen offset:128
    buffer_load_ushort v50, v72, s[40:43], 0 offen offset:256
    buffer_load_ushort v51, v72, s[40:43], 0 offen offset:384
    buffer_load_ushort v52, v72, s[40:43], 0 offen offset:512
    buffer_load_ushort v53, v72, s[40:43], 0 offen offset:640
    buffer_load_ushort v54, v72, s[40:43], 0 offen offset:768
    buffer_load_ushort v55, v72, s[40:43], 0 offen offset:896
    s_waitcnt vmcnt(0)
    v_lshl_or_b32 v32, v49, 16, v48
    v_lshl_or_b32 v33, v51, 16, v50
    v_lshl_or_b32 v34, v53, 16, v52
    v_lshl_or_b32 v35, v55, 16, v54
    buffer_load_ushort v48, v72, s[40:43], 0 offen offset:32
    buffer_load_ushort v49, v72, s[40:43], 0 offen offset:160
    buffer_load_ushort v50, v72, s[40:43], 0 offen offset:288
    buffer_load_ushort v51, v72, s[40:43], 0 offen offset:416
    buffer_load_ushort v52, v72, s[40:43], 0 offen offset:544
    buffer_load_ushort v53, v72, s[40:43], 0 offen offset:672
    buffer_load_ushort v54, v72, s[40:43], 0 offen offset:800
    buffer_load_ushort v55, v72, s[40:43], 0 offen offset:928
    s_waitcnt vmcnt(0)
    v_lshl_or_b32 v36, v49, 16, v48
    v_lshl_or_b32 v37, v51, 16, v50
    v_lshl_or_b32 v38, v53, 16, v52
    v_lshl_or_b32 v39, v55, 16, v54
    buffer_load_ushort v48, v72, s[40:43], 0 offen offset:64
    buffer_load_ushort v49, v72, s[40:43], 0 offen offset:192
    buffer_load_ushort v50, v72, s[40:43], 0 offen offset:320
    buffer_load_ushort v51, v72, s[40:43], 0 offen offset:448
    buffer_load_ushort v52, v72, s[40:43], 0 offen offset:576
    buffer_load_ushort v53, v72, s[40:43], 0 offen offset:704
    buffer_load_ushort v54, v72, s[40:43], 0 offen offset:832
    buffer_load_ushort v55, v72, s[40:43], 0 offen offset:960
    s_waitcnt vmcnt(0)
    v_lshl_or_b32 v40, v49, 16, v48
    v_lshl_or_b32 v41, v51, 16, v50
    v_lshl_or_b32 v42, v53, 16, v52
    v_lshl_or_b32 v43, v55, 16, v54
    buffer_load_ushort v48, v72, s[40:43], 0 offen offset:96
    buffer_load_ushort v49, v72, s[40:43], 0 offen offset:224
    buffer_load_ushort v50, v72, s[40:43], 0 offen offset:352
    buffer_load_ushort v51, v72, s[40:43], 0 offen offset:480
    buffer_load_ushort v52, v72, s[40:43], 0 offen offset:608
    buffer_load_ushort v53, v72, s[40:43], 0 offen offset:736
    buffer_load_ushort v54, v72, s[40:43], 0 offen offset:864
    buffer_load_ushort v55, v72, s[40:43], 0 offen offset:992
    s_waitcnt vmcnt(0)
    v_lshl_or_b32 v44, v49, 16, v48
    v_lshl_or_b32 v45, v51, 16, v50
    v_lshl_or_b32 v46, v53, 16, v52
    v_lshl_or_b32 v47, v55, 16, v54
    v_lshlrev_b32 v6, 6, s2
    v_lshl_add_u32 v6, v2, 4, v6
    v_add_u32 v6, v6, v3
    v_lshlrev_b32 v7, 7, v6
    v_lshl_add_u32 v7, v4, 4, v7
    buffer_load_dwordx4 v[8:11], v7, s[36:39], 0 offen
    buffer_load_dwordx4 v[12:15], v7, s[36:39], 0 offen offset:64
    s_waitcnt vmcnt(0)
    v_mfma_f32_16x16x32_bf16 v[56:59], v[16:19], v[8:11], 0
    v_mfma_f32_16x16x32_bf16 v[56:59], v[32:35], v[12:15], v[56:59]
    v_mfma_f32_16x16x32_bf16 v[60:63], v[20:23], v[8:11], 0
    v_mfma_f32_16x16x32_bf16 v[60:63], v[36:39], v[12:15], v[60:63]
    v_mfma_f32_16x16x32_bf16 v[64:67], v[24:27], v[8:11], 0
    v_mfma_f32_16x16x32_bf16 v[64:67], v[40:43], v[12:15], v[64:67]
    v_mfma_f32_16x16x32_bf16 v[68:71], v[28:31], v[8:11], 0
    v_mfma_f32_16x16x32_bf16 v[68:71], v[44:47], v[12:15], v[68:71]
    s_nop 15
    v_lshlrev_b32 v7, 8, v6
    v_lshl_add_u32 v7, v4, 4, v7
    buffer_store_dwordx4 v[56:59], v7, s[44:47], 0 offen offset:0
    buffer_store_dwordx4 v[60:63], v7, s[44:47], 0 offen offset:64
    buffer_store_dwordx4 v[64:67], v7, s[44:47], 0 offen offset:128
    buffer_store_dwordx4 v[68:71], v7, s[44:47], 0 offen offset:192
    s_cmp_ge_u32 s2, 7
    s_cbranch_scc1 K0_END
    v_lshlrev_b32 v1, 8, s2
    v_add_u32 v1, v1, v0
    v_and_b32 v2, 63, v1
    v_lshrrev_b32 v3, 6, v1
    v_and_b32 v4, 15, v2
    v_lshrrev_b32 v5, 4, v2
    v_and_b32 v6, 3, v3
    v_lshrrev_b32 v7, 2, v3
    v_lshl_add_u32 v8, v6, 4, v4
    v_lshlrev_b32 v8, 1, v8
    v_lshlrev_b32 v9, 5, v7
    v_lshl_add_u32 v9, v5, 3, v9
    v_add_u32 v10, 64, v9
    v_lshl_add_u32 v11, v5, 3, 0
    v_add_u32 v11, 129, v11
    v_cmp_eq_u32 vcc, 2, v7
    s_nop 1
    v_cndmask_b32 v10, v10, v11, vcc
    v_subrev_u32 v12, 96, v9
    v_cmp_gt_u32 vcc, 12, v3
    s_nop 1
    v_cndmask_b32 v10, v12, v10, vcc
    v_lshl_add_u32 v13, v10, 7, v8
    v_mov_b32 v16, 0
    v_mov_b32 v17, 0
    v_mov_b32 v18, 0
    v_mov_b32 v19, 0
    v_mov_b32 v20, 0
    v_mov_b32 v21, 0
    v_mov_b32 v22, 0
    v_mov_b32 v23, 0
    s_and_saveexec_b64 s[60:61], vcc
    s_cbranch_execz K0_C1
    v_cmp_ne_u32 vcc, 2, v7
    v_cmp_gt_u32 s[62:63], 2, v5
    s_or_b64 vcc, vcc, s[62:63]
    s_and_b64 exec, exec, vcc
    s_cbranch_execz K0_C1
    buffer_load_ushort v16, v13, s[40:43], 0 offen offset:0
    buffer_load_ushort v17, v13, s[40:43], 0 offen offset:128
    buffer_load_ushort v18, v13, s[40:43], 0 offen offset:256
    buffer_load_ushort v19, v13, s[40:43], 0 offen offset:384
    buffer_load_ushort v20, v13, s[40:43], 0 offen offset:512
    buffer_load_ushort v21, v13, s[40:43], 0 offen offset:640
    buffer_load_ushort v22, v13, s[40:43], 0 offen offset:768
    buffer_load_ushort v23, v13, s[40:43], 0 offen offset:896
K0_C1:
    s_mov_b64 exec, -1
    v_cmp_eq_u32 vcc, 2, v7
    v_cmp_eq_u32 s[62:63], 2, v5
    s_and_b64 vcc, vcc, s[62:63]
    s_and_saveexec_b64 s[60:61], vcc
    s_cbranch_execz K0_C2
    v_add_u32 v14, 16384, v8
    buffer_load_ushort v16, v14, s[40:43], 0 offen
K0_C2:
    s_mov_b64 exec, -1
    v_cmp_le_u32 vcc, 12, v3
    s_and_saveexec_b64 s[60:61], vcc
    s_cbranch_execz K0_C3
    buffer_load_ushort v16, v13, s[48:51], 0 offen offset:0
    buffer_load_ushort v17, v13, s[48:51], 0 offen offset:128
    buffer_load_ushort v18, v13, s[48:51], 0 offen offset:256
    buffer_load_ushort v19, v13, s[48:51], 0 offen offset:384
    buffer_load_ushort v20, v13, s[48:51], 0 offen offset:512
    buffer_load_ushort v21, v13, s[48:51], 0 offen offset:640
    buffer_load_ushort v22, v13, s[48:51], 0 offen offset:768
    buffer_load_ushort v23, v13, s[48:51], 0 offen offset:896
K0_C3:
    s_mov_b64 exec, -1
    s_waitcnt vmcnt(0)
    v_lshl_or_b32 v24, v17, 16, v16
    v_lshl_or_b32 v25, v19, 16, v18
    v_lshl_or_b32 v26, v21, 16, v20
    v_lshl_or_b32 v27, v23, 16, v22
    v_lshlrev_b32 v14, 4, v1
    buffer_store_dwordx4 v[24:27], v14, s[52:55], 0 offen
    v_subrev_u32 v15, 12288, v14
    buffer_store_dwordx4 v[24:27], v15, s[56:59], 0 offen
K0_END:
    s_endpgm
.globl egnn_k1_kernel
.p2align 8
.type egnn_k1_kernel,@function
egnn_k1_kernel:
    s_load_dwordx16 s[4:19], s[0:1], 0
    s_load_dwordx2 s[20:21], s[0:1], 64
    s_load_dwordx2 s[22:23], s[0:1], 80
    s_waitcnt lgkmcnt(0)
    s_cmp_ge_u32 s2, 64
    s_cbranch_scc1 K1_END
    s_mov_b32 s24, s12
    s_mov_b32 s25, s13
    s_mov_b32 s26, 2560000
    s_mov_b32 s27, 0x00020000
    s_mov_b32 s28, s22
    s_mov_b32 s29, s23
    s_mov_b32 s30, 40000
    s_mov_b32 s31, 0x00020000
    s_add_u32 s32, s22, 0x10000
    s_addc_u32 s33, s23, 0
    s_mov_b32 s34, 2560000
    s_mov_b32 s35, 0x00020000
    v_mov_b32 v1, 0
    v_lshlrev_b32 v2, 2, v0
    ds_write_b32 v2, v1 offset:0
    ds_write_b32 v2, v1 offset:4096
    ds_write_b32 v2, v1 offset:8192
    ds_write_b32 v2, v1 offset:12288
    ds_write_b32 v2, v1 offset:16384
    ds_write_b32 v2, v1 offset:20480
    ds_write_b32 v2, v1 offset:24576
    ds_write_b32 v2, v1 offset:28672
    ds_write_b32 v2, v1 offset:32768
    ds_write_b32 v2, v1 offset:36864
    s_mul_i32 s36, s2, 40000
    v_cmp_gt_u32 vcc, 784, v0
    s_mov_b64 s[40:41], vcc
    buffer_load_dword v10, v2, s[24:27], s36 offen offset:0
    v_add_u32 v31, 4096, v2
    v_add_u32 v32, 8192, v2
    v_add_u32 v33, 12288, v2
    v_add_u32 v34, 16384, v2
    v_add_u32 v35, 20480, v2
    v_add_u32 v36, 24576, v2
    v_add_u32 v37, 28672, v2
    v_add_u32 v38, 32768, v2
    v_add_u32 v39, 36864, v2
    buffer_load_dword v11, v31, s[24:27], s36 offen
    buffer_load_dword v12, v32, s[24:27], s36 offen
    buffer_load_dword v13, v33, s[24:27], s36 offen
    buffer_load_dword v14, v34, s[24:27], s36 offen
    buffer_load_dword v15, v35, s[24:27], s36 offen
    buffer_load_dword v16, v36, s[24:27], s36 offen
    buffer_load_dword v17, v37, s[24:27], s36 offen
    buffer_load_dword v18, v38, s[24:27], s36 offen
    buffer_load_dword v19, v39, s[24:27], s36 offen
    s_waitcnt lgkmcnt(0)
    s_barrier
    v_mov_b32 v3, 1
    s_waitcnt vmcnt(0)
    v_lshlrev_b32 v10, 2, v10
    ds_add_rtn_u32 v20, v10, v3
    v_lshlrev_b32 v11, 2, v11
    ds_add_rtn_u32 v21, v11, v3
    v_lshlrev_b32 v12, 2, v12
    ds_add_rtn_u32 v22, v12, v3
    v_lshlrev_b32 v13, 2, v13
    ds_add_rtn_u32 v23, v13, v3
    v_lshlrev_b32 v14, 2, v14
    ds_add_rtn_u32 v24, v14, v3
    v_lshlrev_b32 v15, 2, v15
    ds_add_rtn_u32 v25, v15, v3
    v_lshlrev_b32 v16, 2, v16
    ds_add_rtn_u32 v26, v16, v3
    v_lshlrev_b32 v17, 2, v17
    ds_add_rtn_u32 v27, v17, v3
    v_lshlrev_b32 v18, 2, v18
    ds_add_rtn_u32 v28, v18, v3
    s_mov_b64 exec, s[40:41]
    v_lshlrev_b32 v19, 2, v19
    ds_add_rtn_u32 v29, v19, v3
    s_mov_b64 exec, -1
    s_waitcnt lgkmcnt(0)
    s_barrier
    ds_read_b32 v41, v2 offset:0
    ds_read_b32 v42, v2 offset:4096
    ds_read_b32 v43, v2 offset:8192
    ds_read_b32 v44, v2 offset:12288
    ds_read_b32 v45, v2 offset:16384
    ds_read_b32 v46, v2 offset:20480
    ds_read_b32 v47, v2 offset:24576
    ds_read_b32 v48, v2 offset:28672
    ds_read_b32 v49, v2 offset:32768
    s_mov_b64 exec, s[40:41]
    ds_read_b32 v50, v2 offset:36864
    s_mov_b64 exec, -1
    s_waitcnt lgkmcnt(0)
    buffer_atomic_add v41, v2, s[28:31], 0 offen sc0 sc1
    buffer_atomic_add v42, v31, s[28:31], 0 offen sc0 sc1
    buffer_atomic_add v43, v32, s[28:31], 0 offen sc0 sc1
    buffer_atomic_add v44, v33, s[28:31], 0 offen sc0 sc1
    buffer_atomic_add v45, v34, s[28:31], 0 offen sc0 sc1
    buffer_atomic_add v46, v35, s[28:31], 0 offen sc0 sc1
    buffer_atomic_add v47, v36, s[28:31], 0 offen sc0 sc1
    buffer_atomic_add v48, v37, s[28:31], 0 offen sc0 sc1
    buffer_atomic_add v49, v38, s[28:31], 0 offen sc0 sc1
    s_mov_b64 exec, s[40:41]
    buffer_atomic_add v50, v39, s[28:31], 0 offen sc0 sc1
    s_mov_b64 exec, -1
    s_waitcnt vmcnt(0)
    ds_write_b32 v2, v41 offset:0
    ds_write_b32 v2, v42 offset:4096
    ds_write_b32 v2, v43 offset:8192
    ds_write_b32 v2, v44 offset:12288
    ds_write_b32 v2, v45 offset:16384
    ds_write_b32 v2, v46 offset:20480
    ds_write_b32 v2, v47 offset:24576
    ds_write_b32 v2, v48 offset:28672
    ds_write_b32 v2, v49 offset:32768
    s_mov_b64 exec, s[40:41]
    ds_write_b32 v2, v50 offset:36864
    s_mov_b64 exec, -1
    s_waitcnt lgkmcnt(0)
    s_barrier
    ds_read_b32 v41, v10
    ds_read_b32 v42, v11
    ds_read_b32 v43, v12
    ds_read_b32 v44, v13
    ds_read_b32 v45, v14
    ds_read_b32 v46, v15
    ds_read_b32 v47, v16
    ds_read_b32 v48, v17
    ds_read_b32 v49, v18
    s_mov_b64 exec, s[40:41]
    ds_read_b32 v50, v19
    s_mov_b64 exec, -1
    s_waitcnt lgkmcnt(0)
    v_add_u32 v41, v41, v20
    buffer_store_dword v41, v2, s[32:35], s36 offen
    v_add_u32 v42, v42, v21
    buffer_store_dword v42, v31, s[32:35], s36 offen
    v_add_u32 v43, v43, v22
    buffer_store_dword v43, v32, s[32:35], s36 offen
    v_add_u32 v44, v44, v23
    buffer_store_dword v44, v33, s[32:35], s36 offen
    v_add_u32 v45, v45, v24
    buffer_store_dword v45, v34, s[32:35], s36 offen
    v_add_u32 v46, v46, v25
    buffer_store_dword v46, v35, s[32:35], s36 offen
    v_add_u32 v47, v47, v26
    buffer_store_dword v47, v36, s[32:35], s36 offen
    v_add_u32 v48, v48, v27
    buffer_store_dword v48, v37, s[32:35], s36 offen
    v_add_u32 v49, v49, v28
    buffer_store_dword v49, v38, s[32:35], s36 offen
    s_mov_b64 exec, s[40:41]
    v_add_u32 v50, v50, v29
    buffer_store_dword v50, v39, s[32:35], s36 offen
K1_END:
    s_endpgm
.globl egnn_k2_kernel
.p2align 8
.type egnn_k2_kernel,@function
egnn_k2_kernel:
    s_load_dwordx16 s[4:19], s[0:1], 0
    s_load_dwordx2 s[20:21], s[0:1], 64
    s_load_dwordx2 s[22:23], s[0:1], 80
    s_waitcnt lgkmcnt(0)
    s_cmp_ge_u32 s2, 125
    s_cbranch_scc1 K2_END
    s_mov_b32 s24, s22
    s_mov_b32 s25, s23
    s_mov_b32 s26, 40000
    s_mov_b32 s27, 0x00020000
    s_add_u32 s28, s22, 0x290000
    s_addc_u32 s29, s23, 0
    s_mov_b32 s30, 40004
    s_mov_b32 s31, 0x00020000
    s_mov_b32 s32, s12
    s_mov_b32 s33, s13
    s_mov_b32 s34, 2560000
    s_mov_b32 s35, 0x00020000
    s_add_u32 s36, s22, 0x10000
    s_addc_u32 s37, s23, 0
    s_mov_b32 s38, 2560000
    s_mov_b32 s39, 0x00020000
    s_mov_b32 s40, s10
    s_mov_b32 s41, s11
    s_mov_b32 s42, 2560000
    s_mov_b32 s43, 0x00020000
    s_add_u32 s44, s22, 0x2a0000
    s_addc_u32 s45, s23, 0
    s_mov_b32 s46, 5120000
    s_mov_b32 s47, 0x00020000
    s_mul_i32 s50, s2, 5120
    v_add_u32 v2, s50, v0
    v_add_u32 v48, 0, v2
    v_lshlrev_b32 v3, 2, v48
    buffer_load_dword v53, v3, s[32:35], 0 offen
    buffer_load_dword v58, v3, s[36:39], 0 offen
    buffer_load_dword v63, v3, s[40:43], 0 offen
    v_add_u32 v49, 1024, v2
    v_lshlrev_b32 v3, 2, v49
    buffer_load_dword v54, v3, s[32:35], 0 offen
    buffer_load_dword v59, v3, s[36:39], 0 offen
    buffer_load_dword v64, v3, s[40:43], 0 offen
    v_add_u32 v50, 2048, v2
    v_lshlrev_b32 v3, 2, v50
    buffer_load_dword v55, v3, s[32:35], 0 offen
    buffer_load_dword v60, v3, s[36:39], 0 offen
    buffer_load_dword v65, v3, s[40:43], 0 offen
    v_add_u32 v51, 3072, v2
    v_lshlrev_b32 v3, 2, v51
    buffer_load_dword v56, v3, s[32:35], 0 offen
    buffer_load_dword v61, v3, s[36:39], 0 offen
    buffer_load_dword v66, v3, s[40:43], 0 offen
    v_add_u32 v52, 4096, v2
    v_lshlrev_b32 v3, 2, v52
    buffer_load_dword v57, v3, s[32:35], 0 offen
    buffer_load_dword v62, v3, s[36:39], 0 offen
    buffer_load_dword v67, v3, s[40:43], 0 offen
    v_mul_u32_u24 v1, 40, v0
    buffer_load_dwordx4 v[4:7], v1, s[24:27], 0 offen
    buffer_load_dwordx4 v[8:11], v1, s[24:27], 0 offen offset:16
    buffer_load_dwordx2 v[12:13], v1, s[24:27], 0 offen offset:32
    s_waitcnt vmcnt(0)
    v_mov_b32 v14, 0
    v_add_u32 v15, v14, v4
    v_add_u32 v16, v15, v5
    v_add_u32 v17, v16, v6
    v_add_u32 v18, v17, v7
    v_add_u32 v19, v18, v8
    v_add_u32 v20, v19, v9
    v_add_u32 v21, v20, v10
    v_add_u32 v22, v21, v11
    v_add_u32 v23, v22, v12
    v_add_u32 v24, v23, v13
    v_mov_b32 v25, v24
    s_nop 1
    v_add_u32_dpp v25, v25, v25 row_shr:1 row_mask:0xf bank_mask:0xf
    s_nop 1
    v_add_u32_dpp v25, v25, v25 row_shr:2 row_mask:0xf bank_mask:0xf
    s_nop 1
    v_add_u32_dpp v25, v25, v25 row_shr:4 row_mask:0xf bank_mask:0xf
    s_nop 1
    v_add_u32_dpp v25, v25, v25 row_shr:8 row_mask:0xf bank_mask:0xf
    s_nop 1
    v_add_u32_dpp v25, v25, v25 row_bcast:15 row_mask:0xa bank_mask:0xf
    s_nop 1
    v_add_u32_dpp v25, v25, v25 row_bcast:31 row_mask:0xc bank_mask:0xf
    s_nop 1
    v_lshrrev_b32 v26, 6, v0
    v_and_b32 v27, 63, v0
    v_cmp_eq_u32 vcc, 63, v27
    v_lshlrev_b32 v28, 2, v26
    s_and_saveexec_b64 s[48:49], vcc
    ds_write_b32 v28, v25 offset:40960
    s_mov_b64 exec, -1
    s_waitcnt lgkmcnt(0)
    s_barrier
    v_mov_b32 v29, 0
    ds_read_b128 v[32:35], v29 offset:40960
    ds_read_b128 v[36:39], v29 offset:40976
    ds_read_b128 v[40:43], v29 offset:40992
    ds_read_b128 v[44:47], v29 offset:41008
    s_waitcnt lgkmcnt(0)
    v_sub_u32 v30, v25, v24
    v_cmp_lt_u32 vcc, 0, v26
    s_nop 1
    v_cndmask_b32 v31, 0, v32, vcc
    v_add_u32 v30, v30, v31
    v_cmp_lt_u32 vcc, 1, v26
    s_nop 1
    v_cndmask_b32 v31, 0, v33, vcc
    v_add_u32 v30, v30, v31
    v_cmp_lt_u32 vcc, 2, v26
    s_nop 1
    v_cndmask_b32 v31, 0, v34, vcc
    v_add_u32 v30, v30, v31
    v_cmp_lt_u32 vcc, 3, v26
    s_nop 1
    v_cndmask_b32 v31, 0, v35, vcc
    v_add_u32 v30, v30, v31
    v_cmp_lt_u32 vcc, 4, v26
    s_nop 1
    v_cndmask_b32 v31, 0, v36, vcc
    v_add_u32 v30, v30, v31
    v_cmp_lt_u32 vcc, 5, v26
    s_nop 1
    v_cndmask_b32 v31, 0, v37, vcc
    v_add_u32 v30, v30, v31
    v_cmp_lt_u32 vcc, 6, v26
    s_nop 1
    v_cndmask_b32 v31, 0, v38, vcc
    v_add_u32 v30, v30, v31
    v_cmp_lt_u32 vcc, 7, v26
    s_nop 1
    v_cndmask_b32 v31, 0, v39, vcc
    v_add_u32 v30, v30, v31
    v_cmp_lt_u32 vcc, 8, v26
    s_nop 1
    v_cndmask_b32 v31, 0, v40, vcc
    v_add_u32 v30, v30, v31
    v_cmp_lt_u32 vcc, 9, v26
    s_nop 1
    v_cndmask_b32 v31, 0, v41, vcc
    v_add_u32 v30, v30, v31
    v_cmp_lt_u32 vcc, 10, v26
    s_nop 1
    v_cndmask_b32 v31, 0, v42, vcc
    v_add_u32 v30, v30, v31
    v_cmp_lt_u32 vcc, 11, v26
    s_nop 1
    v_cndmask_b32 v31, 0, v43, vcc
    v_add_u32 v30, v30, v31
    v_cmp_lt_u32 vcc, 12, v26
    s_nop 1
    v_cndmask_b32 v31, 0, v44, vcc
    v_add_u32 v30, v30, v31
    v_cmp_lt_u32 vcc, 13, v26
    s_nop 1
    v_cndmask_b32 v31, 0, v45, vcc
    v_add_u32 v30, v30, v31
    v_cmp_lt_u32 vcc, 14, v26
    s_nop 1
    v_cndmask_b32 v31, 0, v46, vcc
    v_add_u32 v30, v30, v31
    v_cmp_gt_u32 vcc, 1000, v0
    s_and_saveexec_b64 s[48:49], vcc
    v_add_u32 v14, v14, v30
    ds_write_b32 v1, v14 offset:0
    v_add_u32 v15, v15, v30
    ds_write_b32 v1, v15 offset:4
    v_add_u32 v16, v16, v30
    ds_write_b32 v1, v16 offset:8
    v_add_u32 v17, v17, v30
    ds_write_b32 v1, v17 offset:12
    v_add_u32 v18, v18, v30
    ds_write_b32 v1, v18 offset:16
    v_add_u32 v19, v19, v30
    ds_write_b32 v1, v19 offset:20
    v_add_u32 v20, v20, v30
    ds_write_b32 v1, v20 offset:24
    v_add_u32 v21, v21, v30
    ds_write_b32 v1, v21 offset:28
    v_add_u32 v22, v22, v30
    ds_write_b32 v1, v22 offset:32
    v_add_u32 v23, v23, v30
    ds_write_b32 v1, v23 offset:36
    s_cmp_lg_u32 s2, 0
    s_cbranch_scc1 K2_NOOFF
    buffer_store_dwordx4 v[14:17], v1, s[28:31], 0 offen
    buffer_store_dwordx4 v[18:21], v1, s[28:31], 0 offen offset:16
    buffer_store_dwordx2 v[22:23], v1, s[28:31], 0 offen offset:32
    v_cmp_eq_u32 vcc, 999, v0
    s_and_b64 exec, exec, vcc
    v_add_u32 v31, v30, v24
    buffer_store_dword v31, v1, s[28:31], 0 offen offset:40
K2_NOOFF:
    s_mov_b64 exec, -1
    s_waitcnt lgkmcnt(0)
    s_barrier
    s_waitcnt vmcnt(0)
    v_lshlrev_b32 v53, 2, v53
    ds_read_b32 v53, v53
    v_lshlrev_b32 v54, 2, v54
    ds_read_b32 v54, v54
    v_lshlrev_b32 v55, 2, v55
    ds_read_b32 v55, v55
    v_lshlrev_b32 v56, 2, v56
    ds_read_b32 v56, v56
    v_lshlrev_b32 v57, 2, v57
    ds_read_b32 v57, v57
    s_waitcnt lgkmcnt(0)
    v_add_u32 v53, v53, v58
    v_lshlrev_b32 v53, 3, v53
    v_mov_b32 v70, v63
    v_mov_b32 v71, v48
    v_add_u32 v54, v54, v59
    v_lshlrev_b32 v54, 3, v54
    v_mov_b32 v72, v64
    v_mov_b32 v73, v49
    v_add_u32 v55, v55, v60
    v_lshlrev_b32 v55, 3, v55
    v_mov_b32 v74, v65
    v_mov_b32 v75, v50
    v_add_u32 v56, v56, v61
    v_lshlrev_b32 v56, 3, v56
    v_mov_b32 v76, v66
    v_mov_b32 v77, v51
    v_add_u32 v57, v57, v62
    v_lshlrev_b32 v57, 3, v57
    v_mov_b32 v78, v67
    v_mov_b32 v79, v52
    buffer_store_dwordx2 v[70:71], v53, s[44:47], 0 offen
    buffer_store_dwordx2 v[72:73], v54, s[44:47], 0 offen
    buffer_store_dwordx2 v[74:75], v55, s[44:47], 0 offen
    buffer_store_dwordx2 v[76:77], v56, s[44:47], 0 offen
    buffer_store_dwordx2 v[78:79], v57, s[44:47], 0 offen
K2_END:
    s_endpgm
.globl egnn_k3_kernel
.p2align 8
.type egnn_k3_kernel,@function
egnn_k3_kernel:
    s_load_dwordx16 s[4:19], s[0:1], 0
    s_load_dwordx2 s[20:21], s[0:1], 64
    s_load_dwordx2 s[22:23], s[0:1], 80
    s_waitcnt lgkmcnt(0)
    s_cmp_ge_u32 s2, 512
    s_cbranch_scc1 K3_END
    s_add_u32 s24, s22, 0xcc0000
    s_addc_u32 s25, s23, 0
    s_mov_b32 s26, 12288
    s_mov_b32 s27, 0x00020000
    s_mov_b32 s28, s16
    s_mov_b32 s29, s17
    s_mov_b32 s30, 128
    s_mov_b32 s31, 0x00020000
    s_add_u32 s32, s22, 0x2a0000
    s_addc_u32 s33, s23, 0
    s_mov_b32 s34, 5120000
    s_mov_b32 s35, 0x00020000
    s_mov_b32 s36, s4
    s_mov_b32 s37, s5
    s_mov_b32 s38, 1280000
    s_mov_b32 s39, 0x00020000
    s_mov_b32 s40, s8
    s_mov_b32 s41, s9
    s_mov_b32 s42, 20480000
    s_mov_b32 s43, 0x00020000
    s_add_u32 s44, s22, 0x790000
    s_addc_u32 s45, s23, 0
    s_mov_b32 s46, 160000
    s_mov_b32 s47, 0x00020000
    s_add_u32 s48, s22, 0xa40000
    s_addc_u32 s49, s23, 0
    s_mov_b32 s50, 2560000
    s_mov_b32 s51, 0x00020000
    s_add_u32 s52, s22, 0x7c0000
    s_addc_u32 s53, s23, 0
    s_mov_b32 s54, 1280000
    s_mov_b32 s55, 0x00020000
    s_add_u32 s56, s20, 0x138800
    s_addc_u32 s57, s21, 0
    s_mov_b32 s58, 60000
    s_mov_b32 s59, 0x00020000
    s_add_u32 s60, s22, 0x290000
    s_addc_u32 s61, s23, 0
    v_and_b32 v1, 63, v0
    v_lshrrev_b32 v2, 6, v0
    v_and_b32 v3, 15, v1
    v_lshrrev_b32 v4, 4, v1
    v_lshlrev_b32 v5, 4, v4
    v_lshlrev_b32 v6, 3, v4
    v_mov_b32 v7, 0
    v_cmp_gt_u32 s[74:75], 2, v4
    v_cmp_eq_u32 s[76:77], 2, v4
    v_cmp_eq_u32 s[78:79], 0, v3
    v_cmp_eq_u32 s[80:81], 63, v1
    s_mov_b32 s88, 0xbfb8aa3b
    s_mov_b32 s89, 0xbfb8aa3b
    v_readfirstlane_b32 s62, v2
    s_lshl_b32 s63, s2, 2
    s_add_u32 s62, s62, s63
    s_lshl_b32 s63, s62, 2
    s_load_dwordx2 s[84:85], s[60:61], s63
    s_add_u32 s63, s63, 8192
    s_load_dwordx2 s[82:83], s[60:61], s63
    v_lshlrev_b32 v8, 4, v1
    buffer_load_dwordx4 v[64:67], v8, s[24:27], 0 offen offset:0
    buffer_load_dwordx4 v[68:71], v8, s[24:27], 0 offen offset:1024
    buffer_load_dwordx4 v[72:75], v8, s[24:27], 0 offen offset:2048
    buffer_load_dwordx4 v[76:79], v8, s[24:27], 0 offen offset:3072
    v_add_u32 v9, 4096, v8
    buffer_load_dwordx4 v[80:83], v9, s[24:27], 0 offen
    v_add_u32 v9, 5120, v8
    buffer_load_dwordx4 v[84:87], v9, s[24:27], 0 offen
    v_add_u32 v9, 6144, v8
    buffer_load_dwordx4 v[88:91], v9, s[24:27], 0 offen
    v_add_u32 v9, 7168, v8
    buffer_load_dwordx4 v[92:95], v9, s[24:27], 0 offen
    v_add_u32 v9, 8192, v8
    buffer_load_dwordx4 v[96:99], v9, s[24:27], 0 offen
    v_add_u32 v9, 9216, v8
    buffer_load_dwordx4 v[100:103], v9, s[24:27], 0 offen
    v_add_u32 v9, 10240, v8
    buffer_load_dwordx4 v[104:107], v9, s[24:27], 0 offen
    v_add_u32 v9, 11264, v8
    buffer_load_dwordx4 v[108:111], v9, s[24:27], 0 offen
    buffer_load_dwordx2 v[48:49], v6, s[28:31], 0 offen offset:0
    buffer_load_dwordx2 v[50:51], v6, s[28:31], 0 offen offset:32
    buffer_load_dwordx2 v[52:53], v6, s[28:31], 0 offen offset:64
    buffer_load_dwordx2 v[54:55], v6, s[28:31], 0 offen offset:96
    s_waitcnt vmcnt(0)
    v_lshlrev_b32 v112, 16, v48
    v_and_b32 v113, 0xffff0000, v48
    v_lshlrev_b32 v114, 16, v49
    v_and_b32 v115, 0xffff0000, v49
    v_lshlrev_b32 v116, 16, v50
    v_and_b32 v117, 0xffff0000, v50
    v_lshlrev_b32 v118, 16, v51
    v_and_b32 v119, 0xffff0000, v51
    v_lshlrev_b32 v120, 16, v52
    v_and_b32 v121, 0xffff0000, v52
    v_lshlrev_b32 v122, 16, v53
    v_and_b32 v123, 0xffff0000, v53
    v_lshlrev_b32 v124, 16, v54
    v_and_b32 v125, 0xffff0000, v54
    v_lshlrev_b32 v126, 16, v55
    v_and_b32 v127, 0xffff0000, v55
    v_mov_b32 v32, 0
    v_mov_b32 v33, 0
    v_mov_b32 v34, 0
    v_mov_b32 v35, 0
    v_mov_b32 v36, 0
    v_mov_b32 v37, 0
    v_mov_b32 v38, 0
    v_mov_b32 v39, 0
    v_mov_b32 v40, 0
    v_mov_b32 v41, 0
    v_mov_b32 v42, 0
    v_mov_b32 v43, 0
    v_mov_b32 v44, 0
    v_mov_b32 v45, 0
    v_mov_b32 v46, 0
    v_mov_b32 v47, 0
    v_mov_b32 v28, 0
    v_mov_b32 v29, 0
    v_mov_b32 v30, 0
    s_waitcnt lgkmcnt(0)
    s_mov_b32 s70, s62
    s_mov_b32 s71, s84
    s_mov_b32 s72, s85
    v_add_u32 v8, s71, v3
    v_lshlrev_b32 v8, 3, v8
    buffer_load_dwordx2 v[180:181], v8, s[32:35], 0 offen
    buffer_load_dwordx2 v[182:183], v8, s[32:35], 0 offen offset:128
    s_mov_b32 s64, s67
    s_mov_b32 s65, s68
    s_mov_b32 s66, s69
    s_mov_b32 s67, s70
    s_mov_b32 s68, s71
    s_mov_b32 s69, s72
    s_add_u32 s71, s71, 32
    s_cmp_lt_u32 s71, s72
    s_cbranch_scc1 K3_GI1
    s_add_u32 s70, s70, 2048
    s_waitcnt lgkmcnt(0)
    s_mov_b32 s71, s82
    s_mov_b32 s72, s83
    s_cmp_lt_u32 s70, 10000
    s_cbranch_scc1 K3_GV1
    s_mov_b32 s70, 10000
    s_mov_b32 s71, 0
    s_mov_b32 s72, 0
K3_GV1:
    s_add_u32 s63, s70, 2048
    s_min_u32 s63, s63, 9999
    s_lshl_b32 s63, s63, 2
    s_load_dwordx2 s[82:83], s[60:61], s63
K3_GI1:
    v_add_u32 v8, s71, v3
    v_lshlrev_b32 v8, 3, v8
    buffer_load_dwordx2 v[236:237], v8, s[32:35], 0 offen
    buffer_load_dwordx2 v[238:239], v8, s[32:35], 0 offen offset:128
    s_waitcnt vmcnt(2)
    v_lshl_add_u32 v8, v180, 7, v5
    buffer_load_dwordx4 v[128:131], v8, s[36:39], 0 offen
    buffer_load_dwordx4 v[132:135], v8, s[36:39], 0 offen offset:64
    v_lshl_add_u32 v9, v181, 5, v5
    v_cndmask_b32 v9, -1, v9, s[74:75]
    buffer_load_dwordx4 v[136:139], v9, s[40:43], 0 offen
    v_lshlrev_b32 v10, 4, v180
    buffer_load_dwordx4 v[140:143], v10, s[44:47], 0 offen
    v_lshl_add_u32 v8, v182, 7, v5
    buffer_load_dwordx4 v[144:147], v8, s[36:39], 0 offen
    buffer_load_dwordx4 v[148:151], v8, s[36:39], 0 offen offset:64
    v_lshl_add_u32 v9, v183, 5, v5
    v_cndmask_b32 v9, -1, v9, s[74:75]
    buffer_load_dwordx4 v[152:155], v9, s[40:43], 0 offen
    v_lshlrev_b32 v10, 4, v182
    buffer_load_dwordx4 v[156:159], v10, s[44:47], 0 offen
    s_lshl_b32 s73, s67, 8
    buffer_load_dwordx4 v[160:163], v5, s[48:51], s73 offen offset:0
    buffer_load_dwordx4 v[164:167], v5, s[48:51], s73 offen offset:64
    buffer_load_dwordx4 v[168:171], v5, s[48:51], s73 offen offset:128
    buffer_load_dwordx4 v[172:175], v5, s[48:51], s73 offen offset:192
    s_lshl_b32 s73, s67, 4
    buffer_load_dwordx4 v[176:179], v7, s[44:47], s73 offen
K3_LOOP:
    s_mov_b32 s64, s67
    s_mov_b32 s65, s68
    s_mov_b32 s66, s69
    s_mov_b32 s67, s70
    s_mov_b32 s68, s71
    s_mov_b32 s69, s72
    s_add_u32 s71, s71, 32
    s_cmp_lt_u32 s71, s72
    s_cbranch_scc1 K3_GI2
    s_add_u32 s70, s70, 2048
    s_waitcnt lgkmcnt(0)
    s_mov_b32 s71, s82
    s_mov_b32 s72, s83
    s_cmp_lt_u32 s70, 10000
    s_cbranch_scc1 K3_GV2
    s_mov_b32 s70, 10000
    s_mov_b32 s71, 0
    s_mov_b32 s72, 0
K3_GV2:
    s_add_u32 s63, s70, 2048
    s_min_u32 s63, s63, 9999
    s_lshl_b32 s63, s63, 2
    s_load_dwordx2 s[82:83], s[60:61], s63
K3_GI2:
    s_cmp_ge_u32 s64, 10000
    s_cbranch_scc1 K3_END
    v_add_u32 v8, s71, v3
    v_lshlrev_b32 v8, 3, v8
    buffer_load_dwordx2 v[180:181], v8, s[32:35], 0 offen
    buffer_load_dwordx2 v[182:183], v8, s[32:35], 0 offen offset:128
    s_waitcnt vmcnt(15)
    v_lshl_add_u32 v8, v236, 7, v5
    buffer_load_dwordx4 v[184:187], v8, s[36:39], 0 offen
    buffer_load_dwordx4 v[188:191], v8, s[36:39], 0 offen offset:64
    v_lshl_add_u32 v9, v237, 5, v5
    v_cndmask_b32 v9, -1, v9, s[74:75]
    buffer_load_dwordx4 v[192:195], v9, s[40:43], 0 offen
    v_lshlrev_b32 v10, 4, v236
    buffer_load_dwordx4 v[196:199], v10, s[44:47], 0 offen
    v_lshl_add_u32 v8, v238, 7, v5
    buffer_load_dwordx4 v[200:203], v8, s[36:39], 0 offen
    buffer_load_dwordx4 v[204:207], v8, s[36:39], 0 offen offset:64
    v_lshl_add_u32 v9, v239, 5, v5
    v_cndmask_b32 v9, -1, v9, s[74:75]
    buffer_load_dwordx4 v[208:211], v9, s[40:43], 0 offen
    v_lshlrev_b32 v10, 4, v238
    buffer_load_dwordx4 v[212:215], v10, s[44:47], 0 offen
    s_lshl_b32 s73, s67, 8
    buffer_load_dwordx4 v[216:219], v5, s[48:51], s73 offen offset:0
    buffer_load_dwordx4 v[220:223], v5, s[48:51], s73 offen offset:64
    buffer_load_dwordx4 v[224:227], v5, s[48:51], s73 offen offset:128
    buffer_load_dwordx4 v[228:231], v5, s[48:51], s73 offen offset:192
    s_lshl_b32 s73, s67, 4
    buffer_load_dwordx4 v[232:235], v7, s[44:47], s73 offen
    s_waitcnt vmcnt(15)
    v_add_u32 v8, s65, v3
    v_cmp_gt_u32 s[86:87], s66, v8
    v_sub_f32 v16, v176, v140
    v_sub_f32 v17, v177, v141
    v_sub_f32 v18, v178, v142
    v_cvt_pk_bf16_f32 v15, v16, v17
    v_cvt_pk_bf16_f32 v19, v18, v18
    v_lshlrev_b32 v16, 16, v15
    v_and_b32 v17, 0xffff0000, v15
    v_lshlrev_b32 v18, 16, v19
    v_mul_f32 v20, v16, v16
    v_fmac_f32 v20, v17, v17
    v_fmac_f32 v20, v18, v18
    v_cvt_pk_bf16_f32 v15, v20, v20
    v_and_b32 v15, 0xffff, v15
    v_cndmask_b32 v136, v136, v15, s[76:77]
    v_mfma_f32_16x16x32_bf16 v[48:51], v[64:67], v[128:131], v[160:163]
    v_mfma_f32_16x16x32_bf16 v[52:55], v[68:71], v[128:131], v[164:167]
    v_mfma_f32_16x16x32_bf16 v[56:59], v[72:75], v[128:131], v[168:171]
    v_mfma_f32_16x16x32_bf16 v[60:63], v[76:79], v[128:131], v[172:175]
    v_mfma_f32_16x16x32_bf16 v[48:51], v[80:83], v[132:135], v[48:51]
    v_mfma_f32_16x16x32_bf16 v[52:55], v[84:87], v[132:135], v[52:55]
    v_mfma_f32_16x16x32_bf16 v[56:59], v[88:91], v[132:135], v[56:59]
    v_mfma_f32_16x16x32_bf16 v[60:63], v[92:95], v[132:135], v[60:63]
    v_mfma_f32_16x16x32_bf16 v[48:51], v[96:99], v[136:139], v[48:51]
    v_mfma_f32_16x16x32_bf16 v[52:55], v[100:103], v[136:139], v[52:55]
    v_mfma_f32_16x16x32_bf16 v[56:59], v[104:107], v[136:139], v[56:59]
    v_mfma_f32_16x16x32_bf16 v[60:63], v[108:111], v[136:139], v[60:63]
    s_add_u32 s73, s65, 16
    s_cmp_ge_u32 s73, s66
    s_cbranch_scc1 K3_ONE3
    v_add_u32 v8, s65, v3
    v_add_u32 v8, 16, v8
    v_cmp_gt_u32 s[90:91], s66, v8
    v_sub_f32 v9, v176, v156
    v_sub_f32 v10, v177, v157
    v_sub_f32 v11, v178, v158
    v_cvt_pk_bf16_f32 v15, v9, v10
    v_cvt_pk_bf16_f32 v19, v11, v11
    v_lshlrev_b32 v9, 16, v15
    v_and_b32 v10, 0xffff0000, v15
    v_lshlrev_b32 v11, 16, v19
    v_mul_f32 v20, v9, v9
    v_fmac_f32 v20, v10, v10
    v_fmac_f32 v20, v11, v11
    v_cvt_pk_bf16_f32 v15, v20, v20
    v_and_b32 v15, 0xffff, v15
    v_cndmask_b32 v152, v152, v15, s[76:77]
    v_mfma_f32_16x16x32_bf16 v[240:243], v[64:67], v[144:147], v[160:163]
    v_mfma_f32_16x16x32_bf16 v[244:247], v[68:71], v[144:147], v[164:167]
    v_mfma_f32_16x16x32_bf16 v[248:251], v[72:75], v[144:147], v[168:171]
    v_mfma_f32_16x16x32_bf16 v[252:255], v[76:79], v[144:147], v[172:175]
    v_mfma_f32_16x16x32_bf16 v[240:243], v[80:83], v[148:151], v[240:243]
    v_mfma_f32_16x16x32_bf16 v[244:247], v[84:87], v[148:151], v[244:247]
    v_mfma_f32_16x16x32_bf16 v[248:251], v[88:91], v[148:151], v[248:251]
    v_mfma_f32_16x16x32_bf16 v[252:255], v[92:95], v[148:151], v[252:255]
    v_mfma_f32_16x16x32_bf16 v[240:243], v[96:99], v[152:155], v[240:243]
    v_mfma_f32_16x16x32_bf16 v[244:247], v[100:103], v[152:155], v[244:247]
    v_mfma_f32_16x16x32_bf16 v[248:251], v[104:107], v[152:155], v[248:251]
    v_mfma_f32_16x16x32_bf16 v[252:255], v[108:111], v[152:155], v[252:255]
    v_pk_mul_f32 v[20:21], v[48:49], s[88:89]
    v_pk_mul_f32 v[22:23], v[50:51], s[88:89]
    v_pk_mul_f32 v[24:25], v[52:53], s[88:89]
    v_pk_mul_f32 v[26:27], v[54:55], s[88:89]
    v_exp_f32 v20, v20
    v_exp_f32 v21, v21
    v_exp_f32 v22, v22
    v_exp_f32 v23, v23
    v_exp_f32 v24, v24
    v_exp_f32 v25, v25
    v_exp_f32 v26, v26
    v_exp_f32 v27, v27
    v_pk_add_f32 v[20:21], v[20:21], 1.0 op_sel_hi:[1,0]
    v_pk_add_f32 v[22:23], v[22:23], 1.0 op_sel_hi:[1,0]
    v_pk_add_f32 v[24:25], v[24:25], 1.0 op_sel_hi:[1,0]
    v_pk_add_f32 v[26:27], v[26:27], 1.0 op_sel_hi:[1,0]
    v_rcp_f32 v20, v20
    v_rcp_f32 v21, v21
    v_rcp_f32 v22, v22
    v_rcp_f32 v23, v23
    v_rcp_f32 v24, v24
    v_rcp_f32 v25, v25
    v_rcp_f32 v26, v26
    v_rcp_f32 v27, v27
    v_pk_mul_f32 v[48:49], v[48:49], v[20:21]
    v_pk_mul_f32 v[50:51], v[50:51], v[22:23]
    v_pk_mul_f32 v[52:53], v[52:53], v[24:25]
    v_pk_mul_f32 v[54:55], v[54:55], v[26:27]
    v_pk_mul_f32 v[20:21], v[56:57], s[88:89]
    v_pk_mul_f32 v[22:23], v[58:59], s[88:89]
    v_pk_mul_f32 v[24:25], v[60:61], s[88:89]
    v_pk_mul_f32 v[26:27], v[62:63], s[88:89]
    v_exp_f32 v20, v20
    v_exp_f32 v21, v21
    v_exp_f32 v22, v22
    v_exp_f32 v23, v23
    v_exp_f32 v24, v24
    v_exp_f32 v25, v25
    v_exp_f32 v26, v26
    v_exp_f32 v27, v27
    v_pk_add_f32 v[20:21], v[20:21], 1.0 op_sel_hi:[1,0]
    v_pk_add_f32 v[22:23], v[22:23], 1.0 op_sel_hi:[1,0]
    v_pk_add_f32 v[24:25], v[24:25], 1.0 op_sel_hi:[1,0]
    v_pk_add_f32 v[26:27], v[26:27], 1.0 op_sel_hi:[1,0]
    v_rcp_f32 v20, v20
    v_rcp_f32 v21, v21
    v_rcp_f32 v22, v22
    v_rcp_f32 v23, v23
    v_rcp_f32 v24, v24
    v_rcp_f32 v25, v25
    v_rcp_f32 v26, v26
    v_rcp_f32 v27, v27
    v_pk_mul_f32 v[56:57], v[56:57], v[20:21]
    v_pk_mul_f32 v[58:59], v[58:59], v[22:23]
    v_pk_mul_f32 v[60:61], v[60:61], v[24:25]
    v_pk_mul_f32 v[62:63], v[62:63], v[26:27]
    s_mov_b64 exec, s[86:87]
    v_pk_add_f32 v[32:33], v[32:33], v[48:49]
    v_pk_mul_f32 v[20:21], v[112:113], v[48:49]
    v_pk_add_f32 v[34:35], v[34:35], v[50:51]
    v_pk_fma_f32 v[20:21], v[114:115], v[50:51], v[20:21]
    v_pk_add_f32 v[36:37], v[36:37], v[52:53]
    v_pk_fma_f32 v[20:21], v[116:117], v[52:53], v[20:21]
    v_pk_add_f32 v[38:39], v[38:39], v[54:55]
    v_pk_fma_f32 v[20:21], v[118:119], v[54:55], v[20:21]
    v_pk_add_f32 v[40:41], v[40:41], v[56:57]
    v_pk_fma_f32 v[20:21], v[120:121], v[56:57], v[20:21]
    v_pk_add_f32 v[42:43], v[42:43], v[58:59]
    v_pk_fma_f32 v[20:21], v[122:123], v[58:59], v[20:21]
    v_pk_add_f32 v[44:45], v[44:45], v[60:61]
    v_pk_fma_f32 v[20:21], v[124:125], v[60:61], v[20:21]
    v_pk_add_f32 v[46:47], v[46:47], v[62:63]
    v_pk_fma_f32 v[20:21], v[126:127], v[62:63], v[20:21]
    v_add_f32 v15, v20, v21
    v_fmac_f32 v28, v16, v15
    v_fmac_f32 v29, v17, v15
    v_fmac_f32 v30, v18, v15
    s_mov_b64 exec, -1
    v_pk_mul_f32 v[20:21], v[240:241], s[88:89]
    v_pk_mul_f32 v[22:23], v[242:243], s[88:89]
    v_pk_mul_f32 v[24:25], v[244:245], s[88:89]
    v_pk_mul_f32 v[26:27], v[246:247], s[88:89]
    v_exp_f32 v20, v20
    v_exp_f32 v21, v21
    v_exp_f32 v22, v22
    v_exp_f32 v23, v23
    v_exp_f32 v24, v24
    v_exp_f32 v25, v25
    v_exp_f32 v26, v26
    v_exp_f32 v27, v27
    v_pk_add_f32 v[20:21], v[20:21], 1.0 op_sel_hi:[1,0]
    v_pk_add_f32 v[22:23], v[22:23], 1.0 op_sel_hi:[1,0]
    v_pk_add_f32 v[24:25], v[24:25], 1.0 op_sel_hi:[1,0]
    v_pk_add_f32 v[26:27], v[26:27], 1.0 op_sel_hi:[1,0]
    v_rcp_f32 v20, v20
    v_rcp_f32 v21, v21
    v_rcp_f32 v22, v22
    v_rcp_f32 v23, v23
    v_rcp_f32 v24, v24
    v_rcp_f32 v25, v25
    v_rcp_f32 v26, v26
    v_rcp_f32 v27, v27
    v_pk_mul_f32 v[240:241], v[240:241], v[20:21]
    v_pk_mul_f32 v[242:243], v[242:243], v[22:23]
    v_pk_mul_f32 v[244:245], v[244:245], v[24:25]
    v_pk_mul_f32 v[246:247], v[246:247], v[26:27]
    v_pk_mul_f32 v[20:21], v[248:249], s[88:89]
    v_pk_mul_f32 v[22:23], v[250:251], s[88:89]
    v_pk_mul_f32 v[24:25], v[252:253], s[88:89]
    v_pk_mul_f32 v[26:27], v[254:255], s[88:89]
    v_exp_f32 v20, v20
    v_exp_f32 v21, v21
    v_exp_f32 v22, v22
    v_exp_f32 v23, v23
    v_exp_f32 v24, v24
    v_exp_f32 v25, v25
    v_exp_f32 v26, v26
    v_exp_f32 v27, v27
    v_pk_add_f32 v[20:21], v[20:21], 1.0 op_sel_hi:[1,0]
    v_pk_add_f32 v[22:23], v[22:23], 1.0 op_sel_hi:[1,0]
    v_pk_add_f32 v[24:25], v[24:25], 1.0 op_sel_hi:[1,0]
    v_pk_add_f32 v[26:27], v[26:27], 1.0 op_sel_hi:[1,0]
    v_rcp_f32 v20, v20
    v_rcp_f32 v21, v21
    v_rcp_f32 v22, v22
    v_rcp_f32 v23, v23
    v_rcp_f32 v24, v24
    v_rcp_f32 v25, v25
    v_rcp_f32 v26, v26
    v_rcp_f32 v27, v27
    v_pk_mul_f32 v[248:249], v[248:249], v[20:21]
    v_pk_mul_f32 v[250:251], v[250:251], v[22:23]
    v_pk_mul_f32 v[252:253], v[252:253], v[24:25]
    v_pk_mul_f32 v[254:255], v[254:255], v[26:27]
    s_mov_b64 exec, s[90:91]
    v_pk_add_f32 v[32:33], v[32:33], v[240:241]
    v_pk_mul_f32 v[20:21], v[112:113], v[240:241]
    v_pk_add_f32 v[34:35], v[34:35], v[242:243]
    v_pk_fma_f32 v[20:21], v[114:115], v[242:243], v[20:21]
    v_pk_add_f32 v[36:37], v[36:37], v[244:245]
    v_pk_fma_f32 v[20:21], v[116:117], v[244:245], v[20:21]
    v_pk_add_f32 v[38:39], v[38:39], v[246:247]
    v_pk_fma_f32 v[20:21], v[118:119], v[246:247], v[20:21]
    v_pk_add_f32 v[40:41], v[40:41], v[248:249]
    v_pk_fma_f32 v[20:21], v[120:121], v[248:249], v[20:21]
    v_pk_add_f32 v[42:43], v[42:43], v[250:251]
    v_pk_fma_f32 v[20:21], v[122:123], v[250:251], v[20:21]
    v_pk_add_f32 v[44:45], v[44:45], v[252:253]
    v_pk_fma_f32 v[20:21], v[124:125], v[252:253], v[20:21]
    v_pk_add_f32 v[46:47], v[46:47], v[254:255]
    v_pk_fma_f32 v[20:21], v[126:127], v[254:255], v[20:21]
    v_add_f32 v15, v20, v21
    v_fmac_f32 v28, v9, v15
    v_fmac_f32 v29, v10, v15
    v_fmac_f32 v30, v11, v15
    s_mov_b64 exec, -1
    s_branch K3_SKIP3
K3_ONE3:
    s_nop 4
    v_pk_mul_f32 v[20:21], v[48:49], s[88:89]
    v_pk_mul_f32 v[22:23], v[50:51], s[88:89]
    v_pk_mul_f32 v[24:25], v[52:53], s[88:89]
    v_pk_mul_f32 v[26:27], v[54:55], s[88:89]
    v_exp_f32 v20, v20
    v_exp_f32 v21, v21
    v_exp_f32 v22, v22
    v_exp_f32 v23, v23
    v_exp_f32 v24, v24
    v_exp_f32 v25, v25
    v_exp_f32 v26, v26
    v_exp_f32 v27, v27
    v_pk_add_f32 v[20:21], v[20:21], 1.0 op_sel_hi:[1,0]
    v_pk_add_f32 v[22:23], v[22:23], 1.0 op_sel_hi:[1,0]
    v_pk_add_f32 v[24:25], v[24:25], 1.0 op_sel_hi:[1,0]
    v_pk_add_f32 v[26:27], v[26:27], 1.0 op_sel_hi:[1,0]
    v_rcp_f32 v20, v20
    v_rcp_f32 v21, v21
    v_rcp_f32 v22, v22
    v_rcp_f32 v23, v23
    v_rcp_f32 v24, v24
    v_rcp_f32 v25, v25
    v_rcp_f32 v26, v26
    v_rcp_f32 v27, v27
    v_pk_mul_f32 v[48:49], v[48:49], v[20:21]
    v_pk_mul_f32 v[50:51], v[50:51], v[22:23]
    v_pk_mul_f32 v[52:53], v[52:53], v[24:25]
    v_pk_mul_f32 v[54:55], v[54:55], v[26:27]
    v_pk_mul_f32 v[20:21], v[56:57], s[88:89]
    v_pk_mul_f32 v[22:23], v[58:59], s[88:89]
    v_pk_mul_f32 v[24:25], v[60:61], s[88:89]
    v_pk_mul_f32 v[26:27], v[62:63], s[88:89]
    v_exp_f32 v20, v20
    v_exp_f32 v21, v21
    v_exp_f32 v22, v22
    v_exp_f32 v23, v23
    v_exp_f32 v24, v24
    v_exp_f32 v25, v25
    v_exp_f32 v26, v26
    v_exp_f32 v27, v27
    v_pk_add_f32 v[20:21], v[20:21], 1.0 op_sel_hi:[1,0]
    v_pk_add_f32 v[22:23], v[22:23], 1.0 op_sel_hi:[1,0]
    v_pk_add_f32 v[24:25], v[24:25], 1.0 op_sel_hi:[1,0]
    v_pk_add_f32 v[26:27], v[26:27], 1.0 op_sel_hi:[1,0]
    v_rcp_f32 v20, v20
    v_rcp_f32 v21, v21
    v_rcp_f32 v22, v22
    v_rcp_f32 v23, v23
    v_rcp_f32 v24, v24
    v_rcp_f32 v25, v25
    v_rcp_f32 v26, v26
    v_rcp_f32 v27, v27
    v_pk_mul_f32 v[56:57], v[56:57], v[20:21]
    v_pk_mul_f32 v[58:59], v[58:59], v[22:23]
    v_pk_mul_f32 v[60:61], v[60:61], v[24:25]
    v_pk_mul_f32 v[62:63], v[62:63], v[26:27]
    s_mov_b64 exec, s[86:87]
    v_pk_add_f32 v[32:33], v[32:33], v[48:49]
    v_pk_mul_f32 v[20:21], v[112:113], v[48:49]
    v_pk_add_f32 v[34:35], v[34:35], v[50:51]
    v_pk_fma_f32 v[20:21], v[114:115], v[50:51], v[20:21]
    v_pk_add_f32 v[36:37], v[36:37], v[52:53]
    v_pk_fma_f32 v[20:21], v[116:117], v[52:53], v[20:21]
    v_pk_add_f32 v[38:39], v[38:39], v[54:55]
    v_pk_fma_f32 v[20:21], v[118:119], v[54:55], v[20:21]
    v_pk_add_f32 v[40:41], v[40:41], v[56:57]
    v_pk_fma_f32 v[20:21], v[120:121], v[56:57], v[20:21]
    v_pk_add_f32 v[42:43], v[42:43], v[58:59]
    v_pk_fma_f32 v[20:21], v[122:123], v[58:59], v[20:21]
    v_pk_add_f32 v[44:45], v[44:45], v[60:61]
    v_pk_fma_f32 v[20:21], v[124:125], v[60:61], v[20:21]
    v_pk_add_f32 v[46:47], v[46:47], v[62:63]
    v_pk_fma_f32 v[20:21], v[126:127], v[62:63], v[20:21]
    v_add_f32 v15, v20, v21
    v_fmac_f32 v28, v16, v15
    v_fmac_f32 v29, v17, v15
    v_fmac_f32 v30, v18, v15
    s_mov_b64 exec, -1
K3_SKIP3:
    s_add_u32 s73, s65, 32
    s_cmp_lt_u32 s73, s66
    s_cbranch_scc1 K3_NOFIN3
    v_add_f32_dpp v32, v32, v32 row_ror:8 row_mask:0xf bank_mask:0xf
    v_add_f32_dpp v33, v33, v33 row_ror:8 row_mask:0xf bank_mask:0xf
    v_add_f32_dpp v34, v34, v34 row_ror:8 row_mask:0xf bank_mask:0xf
    v_add_f32_dpp v35, v35, v35 row_ror:8 row_mask:0xf bank_mask:0xf
    v_add_f32_dpp v36, v36, v36 row_ror:8 row_mask:0xf bank_mask:0xf
    v_add_f32_dpp v37, v37, v37 row_ror:8 row_mask:0xf bank_mask:0xf
    v_add_f32_dpp v38, v38, v38 row_ror:8 row_mask:0xf bank_mask:0xf
    v_add_f32_dpp v39, v39, v39 row_ror:8 row_mask:0xf bank_mask:0xf
    v_add_f32_dpp v40, v40, v40 row_ror:8 row_mask:0xf bank_mask:0xf
    v_add_f32_dpp v41, v41, v41 row_ror:8 row_mask:0xf bank_mask:0xf
    v_add_f32_dpp v42, v42, v42 row_ror:8 row_mask:0xf bank_mask:0xf
    v_add_f32_dpp v43, v43, v43 row_ror:8 row_mask:0xf bank_mask:0xf
    v_add_f32_dpp v44, v44, v44 row_ror:8 row_mask:0xf bank_mask:0xf
    v_add_f32_dpp v45, v45, v45 row_ror:8 row_mask:0xf bank_mask:0xf
    v_add_f32_dpp v46, v46, v46 row_ror:8 row_mask:0xf bank_mask:0xf
    v_add_f32_dpp v47, v47, v47 row_ror:8 row_mask:0xf bank_mask:0xf
    v_add_f32_dpp v28, v28, v28 row_ror:8 row_mask:0xf bank_mask:0xf
    v_add_f32_dpp v29, v29, v29 row_ror:8 row_mask:0xf bank_mask:0xf
    v_add_f32_dpp v30, v30, v30 row_ror:8 row_mask:0xf bank_mask:0xf
    v_add_f32_dpp v32, v32, v32 row_ror:4 row_mask:0xf bank_mask:0xf
    v_add_f32_dpp v33, v33, v33 row_ror:4 row_mask:0xf bank_mask:0xf
    v_add_f32_dpp v34, v34, v34 row_ror:4 row_mask:0xf bank_mask:0xf
    v_add_f32_dpp v35, v35, v35 row_ror:4 row_mask:0xf bank_mask:0xf
    v_add_f32_dpp v36, v36, v36 row_ror:4 row_mask:0xf bank_mask:0xf
    v_add_f32_dpp v37, v37, v37 row_ror:4 row_mask:0xf bank_mask:0xf
    v_add_f32_dpp v38, v38, v38 row_ror:4 row_mask:0xf bank_mask:0xf
    v_add_f32_dpp v39, v39, v39 row_ror:4 row_mask:0xf bank_mask:0xf
    v_add_f32_dpp v40, v40, v40 row_ror:4 row_mask:0xf bank_mask:0xf
    v_add_f32_dpp v41, v41, v41 row_ror:4 row_mask:0xf bank_mask:0xf
    v_add_f32_dpp v42, v42, v42 row_ror:4 row_mask:0xf bank_mask:0xf
    v_add_f32_dpp v43, v43, v43 row_ror:4 row_mask:0xf bank_mask:0xf
    v_add_f32_dpp v44, v44, v44 row_ror:4 row_mask:0xf bank_mask:0xf
    v_add_f32_dpp v45, v45, v45 row_ror:4 row_mask:0xf bank_mask:0xf
    v_add_f32_dpp v46, v46, v46 row_ror:4 row_mask:0xf bank_mask:0xf
    v_add_f32_dpp v47, v47, v47 row_ror:4 row_mask:0xf bank_mask:0xf
    v_add_f32_dpp v28, v28, v28 row_ror:4 row_mask:0xf bank_mask:0xf
    v_add_f32_dpp v29, v29, v29 row_ror:4 row_mask:0xf bank_mask:0xf
    v_add_f32_dpp v30, v30, v30 row_ror:4 row_mask:0xf bank_mask:0xf
    v_add_f32_dpp v32, v32, v32 row_ror:2 row_mask:0xf bank_mask:0xf
    v_add_f32_dpp v33, v33, v33 row_ror:2 row_mask:0xf bank_mask:0xf
    v_add_f32_dpp v34, v34, v34 row_ror:2 row_mask:0xf bank_mask:0xf
    v_add_f32_dpp v35, v35, v35 row_ror:2 row_mask:0xf bank_mask:0xf
    v_add_f32_dpp v36, v36, v36 row_ror:2 row_mask:0xf bank_mask:0xf
    v_add_f32_dpp v37, v37, v37 row_ror:2 row_mask:0xf bank_mask:0xf
    v_add_f32_dpp v38, v38, v38 row_ror:2 row_mask:0xf bank_mask:0xf
    v_add_f32_dpp v39, v39, v39 row_ror:2 row_mask:0xf bank_mask:0xf
    v_add_f32_dpp v40, v40, v40 row_ror:2 row_mask:0xf bank_mask:0xf
    v_add_f32_dpp v41, v41, v41 row_ror:2 row_mask:0xf bank_mask:0xf
    v_add_f32_dpp v42, v42, v42 row_ror:2 row_mask:0xf bank_mask:0xf
    v_add_f32_dpp v43, v43, v43 row_ror:2 row_mask:0xf bank_mask:0xf
    v_add_f32_dpp v44, v44, v44 row_ror:2 row_mask:0xf bank_mask:0xf
    v_add_f32_dpp v45, v45, v45 row_ror:2 row_mask:0xf bank_mask:0xf
    v_add_f32_dpp v46, v46, v46 row_ror:2 row_mask:0xf bank_mask:0xf
    v_add_f32_dpp v47, v47, v47 row_ror:2 row_mask:0xf bank_mask:0xf
    v_add_f32_dpp v28, v28, v28 row_ror:2 row_mask:0xf bank_mask:0xf
    v_add_f32_dpp v29, v29, v29 row_ror:2 row_mask:0xf bank_mask:0xf
    v_add_f32_dpp v30, v30, v30 row_ror:2 row_mask:0xf bank_mask:0xf
    v_add_f32_dpp v32, v32, v32 row_ror:1 row_mask:0xf bank_mask:0xf
    v_add_f32_dpp v33, v33, v33 row_ror:1 row_mask:0xf bank_mask:0xf
    v_add_f32_dpp v34, v34, v34 row_ror:1 row_mask:0xf bank_mask:0xf
    v_add_f32_dpp v35, v35, v35 row_ror:1 row_mask:0xf bank_mask:0xf
    v_add_f32_dpp v36, v36, v36 row_ror:1 row_mask:0xf bank_mask:0xf
    v_add_f32_dpp v37, v37, v37 row_ror:1 row_mask:0xf bank_mask:0xf
    v_add_f32_dpp v38, v38, v38 row_ror:1 row_mask:0xf bank_mask:0xf
    v_add_f32_dpp v39, v39, v39 row_ror:1 row_mask:0xf bank_mask:0xf
    v_add_f32_dpp v40, v40, v40 row_ror:1 row_mask:0xf bank_mask:0xf
    v_add_f32_dpp v41, v41, v41 row_ror:1 row_mask:0xf bank_mask:0xf
    v_add_f32_dpp v42, v42, v42 row_ror:1 row_mask:0xf bank_mask:0xf
    v_add_f32_dpp v43, v43, v43 row_ror:1 row_mask:0xf bank_mask:0xf
    v_add_f32_dpp v44, v44, v44 row_ror:1 row_mask:0xf bank_mask:0xf
    v_add_f32_dpp v45, v45, v45 row_ror:1 row_mask:0xf bank_mask:0xf
    v_add_f32_dpp v46, v46, v46 row_ror:1 row_mask:0xf bank_mask:0xf
    v_add_f32_dpp v47, v47, v47 row_ror:1 row_mask:0xf bank_mask:0xf
    v_add_f32_dpp v28, v28, v28 row_ror:1 row_mask:0xf bank_mask:0xf
    v_add_f32_dpp v29, v29, v29 row_ror:1 row_mask:0xf bank_mask:0xf
    v_add_f32_dpp v30, v30, v30 row_ror:1 row_mask:0xf bank_mask:0xf
    s_nop 1
    v_add_f32_dpp v28, v28, v28 row_bcast:15 row_mask:0xa bank_mask:0xf
    v_add_f32_dpp v29, v29, v29 row_bcast:15 row_mask:0xa bank_mask:0xf
    v_add_f32_dpp v30, v30, v30 row_bcast:15 row_mask:0xa bank_mask:0xf
    s_nop 1
    v_add_f32_dpp v28, v28, v28 row_bcast:31 row_mask:0xc bank_mask:0xf
    v_add_f32_dpp v29, v29, v29 row_bcast:31 row_mask:0xc bank_mask:0xf
    v_add_f32_dpp v30, v30, v30 row_bcast:31 row_mask:0xc bank_mask:0xf
    v_cvt_pk_bf16_f32 v48, v32, v33
    v_cvt_pk_bf16_f32 v49, v34, v35
    v_cvt_pk_bf16_f32 v50, v36, v37
    v_cvt_pk_bf16_f32 v51, v38, v39
    v_cvt_pk_bf16_f32 v52, v40, v41
    v_cvt_pk_bf16_f32 v53, v42, v43
    v_cvt_pk_bf16_f32 v54, v44, v45
    v_cvt_pk_bf16_f32 v55, v46, v47
    v_add_f32 v28, v28, v176
    v_add_f32 v29, v29, v177
    v_add_f32 v30, v30, v178
    v_cvt_pk_bf16_f32 v56, v28, v29
    v_cvt_pk_bf16_f32 v57, v30, v30
    v_lshrrev_b32 v58, 16, v56
    s_lshl_b32 s73, s64, 7
    s_mov_b64 exec, s[78:79]
    buffer_store_dwordx2 v[48:49], v6, s[52:55], s73 offen offset:0
    buffer_store_dwordx2 v[50:51], v6, s[52:55], s73 offen offset:32
    buffer_store_dwordx2 v[52:53], v6, s[52:55], s73 offen offset:64
    buffer_store_dwordx2 v[54:55], v6, s[52:55], s73 offen offset:96
    s_mul_i32 s73, s64, 6
    s_mov_b64 exec, s[80:81]
    buffer_store_short v56, v7, s[56:59], s73 offen
    buffer_store_short v58, v7, s[56:59], s73 offen offset:2
    buffer_store_short v57, v7, s[56:59], s73 offen offset:4
    s_mov_b64 exec, -1
    v_mov_b32 v32, 0
    v_mov_b32 v33, 0
    v_mov_b32 v34, 0
    v_mov_b32 v35, 0
    v_mov_b32 v36, 0
    v_mov_b32 v37, 0
    v_mov_b32 v38, 0
    v_mov_b32 v39, 0
    v_mov_b32 v40, 0
    v_mov_b32 v41, 0
    v_mov_b32 v42, 0
    v_mov_b32 v43, 0
    v_mov_b32 v44, 0
    v_mov_b32 v45, 0
    v_mov_b32 v46, 0
    v_mov_b32 v47, 0
    v_mov_b32 v28, 0
    v_mov_b32 v29, 0
    v_mov_b32 v30, 0
K3_NOFIN3:
    s_mov_b32 s64, s67
    s_mov_b32 s65, s68
    s_mov_b32 s66, s69
    s_mov_b32 s67, s70
    s_mov_b32 s68, s71
    s_mov_b32 s69, s72
    s_add_u32 s71, s71, 32
    s_cmp_lt_u32 s71, s72
    s_cbranch_scc1 K3_GI4
    s_add_u32 s70, s70, 2048
    s_waitcnt lgkmcnt(0)
    s_mov_b32 s71, s82
    s_mov_b32 s72, s83
    s_cmp_lt_u32 s70, 10000
    s_cbranch_scc1 K3_GV4
    s_mov_b32 s70, 10000
    s_mov_b32 s71, 0
    s_mov_b32 s72, 0
K3_GV4:
    s_add_u32 s63, s70, 2048
    s_min_u32 s63, s63, 9999
    s_lshl_b32 s63, s63, 2
    s_load_dwordx2 s[82:83], s[60:61], s63
K3_GI4:
    s_cmp_ge_u32 s64, 10000
    s_cbranch_scc1 K3_END
    v_add_u32 v8, s71, v3
    v_lshlrev_b32 v8, 3, v8
    buffer_load_dwordx2 v[236:237], v8, s[32:35], 0 offen
    buffer_load_dwordx2 v[238:239], v8, s[32:35], 0 offen offset:128
    s_waitcnt vmcnt(15)
    v_lshl_add_u32 v8, v180, 7, v5
    buffer_load_dwordx4 v[128:131], v8, s[36:39], 0 offen
    buffer_load_dwordx4 v[132:135], v8, s[36:39], 0 offen offset:64
    v_lshl_add_u32 v9, v181, 5, v5
    v_cndmask_b32 v9, -1, v9, s[74:75]
    buffer_load_dwordx4 v[136:139], v9, s[40:43], 0 offen
    v_lshlrev_b32 v10, 4, v180
    buffer_load_dwordx4 v[140:143], v10, s[44:47], 0 offen
    v_lshl_add_u32 v8, v182, 7, v5
    buffer_load_dwordx4 v[144:147], v8, s[36:39], 0 offen
    buffer_load_dwordx4 v[148:151], v8, s[36:39], 0 offen offset:64
    v_lshl_add_u32 v9, v183, 5, v5
    v_cndmask_b32 v9, -1, v9, s[74:75]
    buffer_load_dwordx4 v[152:155], v9, s[40:43], 0 offen
    v_lshlrev_b32 v10, 4, v182
    buffer_load_dwordx4 v[156:159], v10, s[44:47], 0 offen
    s_lshl_b32 s73, s67, 8
    buffer_load_dwordx4 v[160:163], v5, s[48:51], s73 offen offset:0
    buffer_load_dwordx4 v[164:167], v5, s[48:51], s73 offen offset:64
    buffer_load_dwordx4 v[168:171], v5, s[48:51], s73 offen offset:128
    buffer_load_dwordx4 v[172:175], v5, s[48:51], s73 offen offset:192
    s_lshl_b32 s73, s67, 4
    buffer_load_dwordx4 v[176:179], v7, s[44:47], s73 offen
    s_waitcnt vmcnt(15)
    v_add_u32 v8, s65, v3
    v_cmp_gt_u32 s[86:87], s66, v8
    v_sub_f32 v16, v232, v196
    v_sub_f32 v17, v233, v197
    v_sub_f32 v18, v234, v198
    v_cvt_pk_bf16_f32 v15, v16, v17
    v_cvt_pk_bf16_f32 v19, v18, v18
    v_lshlrev_b32 v16, 16, v15
    v_and_b32 v17, 0xffff0000, v15
    v_lshlrev_b32 v18, 16, v19
    v_mul_f32 v20, v16, v16
    v_fmac_f32 v20, v17, v17
    v_fmac_f32 v20, v18, v18
    v_cvt_pk_bf16_f32 v15, v20, v20
    v_and_b32 v15, 0xffff, v15
    v_cndmask_b32 v192, v192, v15, s[76:77]
    v_mfma_f32_16x16x32_bf16 v[48:51], v[64:67], v[184:187], v[216:219]
    v_mfma_f32_16x16x32_bf16 v[52:55], v[68:71], v[184:187], v[220:223]
    v_mfma_f32_16x16x32_bf16 v[56:59], v[72:75], v[184:187], v[224:227]
    v_mfma_f32_16x16x32_bf16 v[60:63], v[76:79], v[184:187], v[228:231]
    v_mfma_f32_16x16x32_bf16 v[48:51], v[80:83], v[188:191], v[48:51]
    v_mfma_f32_16x16x32_bf16 v[52:55], v[84:87], v[188:191], v[52:55]
    v_mfma_f32_16x16x32_bf16 v[56:59], v[88:91], v[188:191], v[56:59]
    v_mfma_f32_16x16x32_bf16 v[60:63], v[92:95], v[188:191], v[60:63]
    v_mfma_f32_16x16x32_bf16 v[48:51], v[96:99], v[192:195], v[48:51]
    v_mfma_f32_16x16x32_bf16 v[52:55], v[100:103], v[192:195], v[52:55]
    v_mfma_f32_16x16x32_bf16 v[56:59], v[104:107], v[192:195], v[56:59]
    v_mfma_f32_16x16x32_bf16 v[60:63], v[108:111], v[192:195], v[60:63]
    s_add_u32 s73, s65, 16
    s_cmp_ge_u32 s73, s66
    s_cbranch_scc1 K3_ONE5
    v_add_u32 v8, s65, v3
    v_add_u32 v8, 16, v8
    v_cmp_gt_u32 s[90:91], s66, v8
    v_sub_f32 v9, v232, v212
    v_sub_f32 v10, v233, v213
    v_sub_f32 v11, v234, v214
    v_cvt_pk_bf16_f32 v15, v9, v10
    v_cvt_pk_bf16_f32 v19, v11, v11
    v_lshlrev_b32 v9, 16, v15
    v_and_b32 v10, 0xffff0000, v15
    v_lshlrev_b32 v11, 16, v19
    v_mul_f32 v20, v9, v9
    v_fmac_f32 v20, v10, v10
    v_fmac_f32 v20, v11, v11
    v_cvt_pk_bf16_f32 v15, v20, v20
    v_and_b32 v15, 0xffff, v15
    v_cndmask_b32 v208, v208, v15, s[76:77]
    v_mfma_f32_16x16x32_bf16 v[240:243], v[64:67], v[200:203], v[216:219]
    v_mfma_f32_16x16x32_bf16 v[244:247], v[68:71], v[200:203], v[220:223]
    v_mfma_f32_16x16x32_bf16 v[248:251], v[72:75], v[200:203], v[224:227]
    v_mfma_f32_16x16x32_bf16 v[252:255], v[76:79], v[200:203], v[228:231]
    v_mfma_f32_16x16x32_bf16 v[240:243], v[80:83], v[204:207], v[240:243]
    v_mfma_f32_16x16x32_bf16 v[244:247], v[84:87], v[204:207], v[244:247]
    v_mfma_f32_16x16x32_bf16 v[248:251], v[88:91], v[204:207], v[248:251]
    v_mfma_f32_16x16x32_bf16 v[252:255], v[92:95], v[204:207], v[252:255]
    v_mfma_f32_16x16x32_bf16 v[240:243], v[96:99], v[208:211], v[240:243]
    v_mfma_f32_16x16x32_bf16 v[244:247], v[100:103], v[208:211], v[244:247]
    v_mfma_f32_16x16x32_bf16 v[248:251], v[104:107], v[208:211], v[248:251]
    v_mfma_f32_16x16x32_bf16 v[252:255], v[108:111], v[208:211], v[252:255]
    v_pk_mul_f32 v[20:21], v[48:49], s[88:89]
    v_pk_mul_f32 v[22:23], v[50:51], s[88:89]
    v_pk_mul_f32 v[24:25], v[52:53], s[88:89]
    v_pk_mul_f32 v[26:27], v[54:55], s[88:89]
    v_exp_f32 v20, v20
    v_exp_f32 v21, v21
    v_exp_f32 v22, v22
    v_exp_f32 v23, v23
    v_exp_f32 v24, v24
    v_exp_f32 v25, v25
    v_exp_f32 v26, v26
    v_exp_f32 v27, v27
    v_pk_add_f32 v[20:21], v[20:21], 1.0 op_sel_hi:[1,0]
    v_pk_add_f32 v[22:23], v[22:23], 1.0 op_sel_hi:[1,0]
    v_pk_add_f32 v[24:25], v[24:25], 1.0 op_sel_hi:[1,0]
    v_pk_add_f32 v[26:27], v[26:27], 1.0 op_sel_hi:[1,0]
    v_rcp_f32 v20, v20
    v_rcp_f32 v21, v21
    v_rcp_f32 v22, v22
    v_rcp_f32 v23, v23
    v_rcp_f32 v24, v24
    v_rcp_f32 v25, v25
    v_rcp_f32 v26, v26
    v_rcp_f32 v27, v27
    v_pk_mul_f32 v[48:49], v[48:49], v[20:21]
    v_pk_mul_f32 v[50:51], v[50:51], v[22:23]
    v_pk_mul_f32 v[52:53], v[52:53], v[24:25]
    v_pk_mul_f32 v[54:55], v[54:55], v[26:27]
    v_pk_mul_f32 v[20:21], v[56:57], s[88:89]
    v_pk_mul_f32 v[22:23], v[58:59], s[88:89]
    v_pk_mul_f32 v[24:25], v[60:61], s[88:89]
    v_pk_mul_f32 v[26:27], v[62:63], s[88:89]
    v_exp_f32 v20, v20
    v_exp_f32 v21, v21
    v_exp_f32 v22, v22
    v_exp_f32 v23, v23
    v_exp_f32 v24, v24
    v_exp_f32 v25, v25
    v_exp_f32 v26, v26
    v_exp_f32 v27, v27
    v_pk_add_f32 v[20:21], v[20:21], 1.0 op_sel_hi:[1,0]
    v_pk_add_f32 v[22:23], v[22:23], 1.0 op_sel_hi:[1,0]
    v_pk_add_f32 v[24:25], v[24:25], 1.0 op_sel_hi:[1,0]
    v_pk_add_f32 v[26:27], v[26:27], 1.0 op_sel_hi:[1,0]
    v_rcp_f32 v20, v20
    v_rcp_f32 v21, v21
    v_rcp_f32 v22, v22
    v_rcp_f32 v23, v23
    v_rcp_f32 v24, v24
    v_rcp_f32 v25, v25
    v_rcp_f32 v26, v26
    v_rcp_f32 v27, v27
    v_pk_mul_f32 v[56:57], v[56:57], v[20:21]
    v_pk_mul_f32 v[58:59], v[58:59], v[22:23]
    v_pk_mul_f32 v[60:61], v[60:61], v[24:25]
    v_pk_mul_f32 v[62:63], v[62:63], v[26:27]
    s_mov_b64 exec, s[86:87]
    v_pk_add_f32 v[32:33], v[32:33], v[48:49]
    v_pk_mul_f32 v[20:21], v[112:113], v[48:49]
    v_pk_add_f32 v[34:35], v[34:35], v[50:51]
    v_pk_fma_f32 v[20:21], v[114:115], v[50:51], v[20:21]
    v_pk_add_f32 v[36:37], v[36:37], v[52:53]
    v_pk_fma_f32 v[20:21], v[116:117], v[52:53], v[20:21]
    v_pk_add_f32 v[38:39], v[38:39], v[54:55]
    v_pk_fma_f32 v[20:21], v[118:119], v[54:55], v[20:21]
    v_pk_add_f32 v[40:41], v[40:41], v[56:57]
    v_pk_fma_f32 v[20:21], v[120:121], v[56:57], v[20:21]
    v_pk_add_f32 v[42:43], v[42:43], v[58:59]
    v_pk_fma_f32 v[20:21], v[122:123], v[58:59], v[20:21]
    v_pk_add_f32 v[44:45], v[44:45], v[60:61]
    v_pk_fma_f32 v[20:21], v[124:125], v[60:61], v[20:21]
    v_pk_add_f32 v[46:47], v[46:47], v[62:63]
    v_pk_fma_f32 v[20:21], v[126:127], v[62:63], v[20:21]
    v_add_f32 v15, v20, v21
    v_fmac_f32 v28, v16, v15
    v_fmac_f32 v29, v17, v15
    v_fmac_f32 v30, v18, v15
    s_mov_b64 exec, -1
    v_pk_mul_f32 v[20:21], v[240:241], s[88:89]
    v_pk_mul_f32 v[22:23], v[242:243], s[88:89]
    v_pk_mul_f32 v[24:25], v[244:245], s[88:89]
    v_pk_mul_f32 v[26:27], v[246:247], s[88:89]
    v_exp_f32 v20, v20
    v_exp_f32 v21, v21
    v_exp_f32 v22, v22
    v_exp_f32 v23, v23
    v_exp_f32 v24, v24
    v_exp_f32 v25, v25
    v_exp_f32 v26, v26
    v_exp_f32 v27, v27
    v_pk_add_f32 v[20:21], v[20:21], 1.0 op_sel_hi:[1,0]
    v_pk_add_f32 v[22:23], v[22:23], 1.0 op_sel_hi:[1,0]
    v_pk_add_f32 v[24:25], v[24:25], 1.0 op_sel_hi:[1,0]
    v_pk_add_f32 v[26:27], v[26:27], 1.0 op_sel_hi:[1,0]
    v_rcp_f32 v20, v20
    v_rcp_f32 v21, v21
    v_rcp_f32 v22, v22
    v_rcp_f32 v23, v23
    v_rcp_f32 v24, v24
    v_rcp_f32 v25, v25
    v_rcp_f32 v26, v26
    v_rcp_f32 v27, v27
    v_pk_mul_f32 v[240:241], v[240:241], v[20:21]
    v_pk_mul_f32 v[242:243], v[242:243], v[22:23]
    v_pk_mul_f32 v[244:245], v[244:245], v[24:25]
    v_pk_mul_f32 v[246:247], v[246:247], v[26:27]
    v_pk_mul_f32 v[20:21], v[248:249], s[88:89]
    v_pk_mul_f32 v[22:23], v[250:251], s[88:89]
    v_pk_mul_f32 v[24:25], v[252:253], s[88:89]
    v_pk_mul_f32 v[26:27], v[254:255], s[88:89]
    v_exp_f32 v20, v20
    v_exp_f32 v21, v21
    v_exp_f32 v22, v22
    v_exp_f32 v23, v23
    v_exp_f32 v24, v24
    v_exp_f32 v25, v25
    v_exp_f32 v26, v26
    v_exp_f32 v27, v27
    v_pk_add_f32 v[20:21], v[20:21], 1.0 op_sel_hi:[1,0]
    v_pk_add_f32 v[22:23], v[22:23], 1.0 op_sel_hi:[1,0]
    v_pk_add_f32 v[24:25], v[24:25], 1.0 op_sel_hi:[1,0]
    v_pk_add_f32 v[26:27], v[26:27], 1.0 op_sel_hi:[1,0]
    v_rcp_f32 v20, v20
    v_rcp_f32 v21, v21
    v_rcp_f32 v22, v22
    v_rcp_f32 v23, v23
    v_rcp_f32 v24, v24
    v_rcp_f32 v25, v25
    v_rcp_f32 v26, v26
    v_rcp_f32 v27, v27
    v_pk_mul_f32 v[248:249], v[248:249], v[20:21]
    v_pk_mul_f32 v[250:251], v[250:251], v[22:23]
    v_pk_mul_f32 v[252:253], v[252:253], v[24:25]
    v_pk_mul_f32 v[254:255], v[254:255], v[26:27]
    s_mov_b64 exec, s[90:91]
    v_pk_add_f32 v[32:33], v[32:33], v[240:241]
    v_pk_mul_f32 v[20:21], v[112:113], v[240:241]
    v_pk_add_f32 v[34:35], v[34:35], v[242:243]
    v_pk_fma_f32 v[20:21], v[114:115], v[242:243], v[20:21]
    v_pk_add_f32 v[36:37], v[36:37], v[244:245]
    v_pk_fma_f32 v[20:21], v[116:117], v[244:245], v[20:21]
    v_pk_add_f32 v[38:39], v[38:39], v[246:247]
    v_pk_fma_f32 v[20:21], v[118:119], v[246:247], v[20:21]
    v_pk_add_f32 v[40:41], v[40:41], v[248:249]
    v_pk_fma_f32 v[20:21], v[120:121], v[248:249], v[20:21]
    v_pk_add_f32 v[42:43], v[42:43], v[250:251]
    v_pk_fma_f32 v[20:21], v[122:123], v[250:251], v[20:21]
    v_pk_add_f32 v[44:45], v[44:45], v[252:253]
    v_pk_fma_f32 v[20:21], v[124:125], v[252:253], v[20:21]
    v_pk_add_f32 v[46:47], v[46:47], v[254:255]
    v_pk_fma_f32 v[20:21], v[126:127], v[254:255], v[20:21]
    v_add_f32 v15, v20, v21
    v_fmac_f32 v28, v9, v15
    v_fmac_f32 v29, v10, v15
    v_fmac_f32 v30, v11, v15
    s_mov_b64 exec, -1
    s_branch K3_SKIP5
K3_ONE5:
    s_nop 4
    v_pk_mul_f32 v[20:21], v[48:49], s[88:89]
    v_pk_mul_f32 v[22:23], v[50:51], s[88:89]
    v_pk_mul_f32 v[24:25], v[52:53], s[88:89]
    v_pk_mul_f32 v[26:27], v[54:55], s[88:89]
    v_exp_f32 v20, v20
    v_exp_f32 v21, v21
    v_exp_f32 v22, v22
    v_exp_f32 v23, v23
    v_exp_f32 v24, v24
    v_exp_f32 v25, v25
    v_exp_f32 v26, v26
    v_exp_f32 v27, v27
    v_pk_add_f32 v[20:21], v[20:21], 1.0 op_sel_hi:[1,0]
    v_pk_add_f32 v[22:23], v[22:23], 1.0 op_sel_hi:[1,0]
    v_pk_add_f32 v[24:25], v[24:25], 1.0 op_sel_hi:[1,0]
    v_pk_add_f32 v[26:27], v[26:27], 1.0 op_sel_hi:[1,0]
    v_rcp_f32 v20, v20
    v_rcp_f32 v21, v21
    v_rcp_f32 v22, v22
    v_rcp_f32 v23, v23
    v_rcp_f32 v24, v24
    v_rcp_f32 v25, v25
    v_rcp_f32 v26, v26
    v_rcp_f32 v27, v27
    v_pk_mul_f32 v[48:49], v[48:49], v[20:21]
    v_pk_mul_f32 v[50:51], v[50:51], v[22:23]
    v_pk_mul_f32 v[52:53], v[52:53], v[24:25]
    v_pk_mul_f32 v[54:55], v[54:55], v[26:27]
    v_pk_mul_f32 v[20:21], v[56:57], s[88:89]
    v_pk_mul_f32 v[22:23], v[58:59], s[88:89]
    v_pk_mul_f32 v[24:25], v[60:61], s[88:89]
    v_pk_mul_f32 v[26:27], v[62:63], s[88:89]
    v_exp_f32 v20, v20
    v_exp_f32 v21, v21
    v_exp_f32 v22, v22
    v_exp_f32 v23, v23
    v_exp_f32 v24, v24
    v_exp_f32 v25, v25
    v_exp_f32 v26, v26
    v_exp_f32 v27, v27
    v_pk_add_f32 v[20:21], v[20:21], 1.0 op_sel_hi:[1,0]
    v_pk_add_f32 v[22:23], v[22:23], 1.0 op_sel_hi:[1,0]
    v_pk_add_f32 v[24:25], v[24:25], 1.0 op_sel_hi:[1,0]
    v_pk_add_f32 v[26:27], v[26:27], 1.0 op_sel_hi:[1,0]
    v_rcp_f32 v20, v20
    v_rcp_f32 v21, v21
    v_rcp_f32 v22, v22
    v_rcp_f32 v23, v23
    v_rcp_f32 v24, v24
    v_rcp_f32 v25, v25
    v_rcp_f32 v26, v26
    v_rcp_f32 v27, v27
    v_pk_mul_f32 v[56:57], v[56:57], v[20:21]
    v_pk_mul_f32 v[58:59], v[58:59], v[22:23]
    v_pk_mul_f32 v[60:61], v[60:61], v[24:25]
    v_pk_mul_f32 v[62:63], v[62:63], v[26:27]
    s_mov_b64 exec, s[86:87]
    v_pk_add_f32 v[32:33], v[32:33], v[48:49]
    v_pk_mul_f32 v[20:21], v[112:113], v[48:49]
    v_pk_add_f32 v[34:35], v[34:35], v[50:51]
    v_pk_fma_f32 v[20:21], v[114:115], v[50:51], v[20:21]
    v_pk_add_f32 v[36:37], v[36:37], v[52:53]
    v_pk_fma_f32 v[20:21], v[116:117], v[52:53], v[20:21]
    v_pk_add_f32 v[38:39], v[38:39], v[54:55]
    v_pk_fma_f32 v[20:21], v[118:119], v[54:55], v[20:21]
    v_pk_add_f32 v[40:41], v[40:41], v[56:57]
    v_pk_fma_f32 v[20:21], v[120:121], v[56:57], v[20:21]
    v_pk_add_f32 v[42:43], v[42:43], v[58:59]
    v_pk_fma_f32 v[20:21], v[122:123], v[58:59], v[20:21]
    v_pk_add_f32 v[44:45], v[44:45], v[60:61]
    v_pk_fma_f32 v[20:21], v[124:125], v[60:61], v[20:21]
    v_pk_add_f32 v[46:47], v[46:47], v[62:63]
    v_pk_fma_f32 v[20:21], v[126:127], v[62:63], v[20:21]
    v_add_f32 v15, v20, v21
    v_fmac_f32 v28, v16, v15
    v_fmac_f32 v29, v17, v15
    v_fmac_f32 v30, v18, v15
    s_mov_b64 exec, -1
K3_SKIP5:
    s_add_u32 s73, s65, 32
    s_cmp_lt_u32 s73, s66
    s_cbranch_scc1 K3_NOFIN5
    v_add_f32_dpp v32, v32, v32 row_ror:8 row_mask:0xf bank_mask:0xf
    v_add_f32_dpp v33, v33, v33 row_ror:8 row_mask:0xf bank_mask:0xf
    v_add_f32_dpp v34, v34, v34 row_ror:8 row_mask:0xf bank_mask:0xf
    v_add_f32_dpp v35, v35, v35 row_ror:8 row_mask:0xf bank_mask:0xf
    v_add_f32_dpp v36, v36, v36 row_ror:8 row_mask:0xf bank_mask:0xf
    v_add_f32_dpp v37, v37, v37 row_ror:8 row_mask:0xf bank_mask:0xf
    v_add_f32_dpp v38, v38, v38 row_ror:8 row_mask:0xf bank_mask:0xf
    v_add_f32_dpp v39, v39, v39 row_ror:8 row_mask:0xf bank_mask:0xf
    v_add_f32_dpp v40, v40, v40 row_ror:8 row_mask:0xf bank_mask:0xf
    v_add_f32_dpp v41, v41, v41 row_ror:8 row_mask:0xf bank_mask:0xf
    v_add_f32_dpp v42, v42, v42 row_ror:8 row_mask:0xf bank_mask:0xf
    v_add_f32_dpp v43, v43, v43 row_ror:8 row_mask:0xf bank_mask:0xf
    v_add_f32_dpp v44, v44, v44 row_ror:8 row_mask:0xf bank_mask:0xf
    v_add_f32_dpp v45, v45, v45 row_ror:8 row_mask:0xf bank_mask:0xf
    v_add_f32_dpp v46, v46, v46 row_ror:8 row_mask:0xf bank_mask:0xf
    v_add_f32_dpp v47, v47, v47 row_ror:8 row_mask:0xf bank_mask:0xf
    v_add_f32_dpp v28, v28, v28 row_ror:8 row_mask:0xf bank_mask:0xf
    v_add_f32_dpp v29, v29, v29 row_ror:8 row_mask:0xf bank_mask:0xf
    v_add_f32_dpp v30, v30, v30 row_ror:8 row_mask:0xf bank_mask:0xf
    v_add_f32_dpp v32, v32, v32 row_ror:4 row_mask:0xf bank_mask:0xf
    v_add_f32_dpp v33, v33, v33 row_ror:4 row_mask:0xf bank_mask:0xf
    v_add_f32_dpp v34, v34, v34 row_ror:4 row_mask:0xf bank_mask:0xf
    v_add_f32_dpp v35, v35, v35 row_ror:4 row_mask:0xf bank_mask:0xf
    v_add_f32_dpp v36, v36, v36 row_ror:4 row_mask:0xf bank_mask:0xf
    v_add_f32_dpp v37, v37, v37 row_ror:4 row_mask:0xf bank_mask:0xf
    v_add_f32_dpp v38, v38, v38 row_ror:4 row_mask:0xf bank_mask:0xf
    v_add_f32_dpp v39, v39, v39 row_ror:4 row_mask:0xf bank_mask:0xf
    v_add_f32_dpp v40, v40, v40 row_ror:4 row_mask:0xf bank_mask:0xf
    v_add_f32_dpp v41, v41, v41 row_ror:4 row_mask:0xf bank_mask:0xf
    v_add_f32_dpp v42, v42, v42 row_ror:4 row_mask:0xf bank_mask:0xf
    v_add_f32_dpp v43, v43, v43 row_ror:4 row_mask:0xf bank_mask:0xf
    v_add_f32_dpp v44, v44, v44 row_ror:4 row_mask:0xf bank_mask:0xf
    v_add_f32_dpp v45, v45, v45 row_ror:4 row_mask:0xf bank_mask:0xf
    v_add_f32_dpp v46, v46, v46 row_ror:4 row_mask:0xf bank_mask:0xf
    v_add_f32_dpp v47, v47, v47 row_ror:4 row_mask:0xf bank_mask:0xf
    v_add_f32_dpp v28, v28, v28 row_ror:4 row_mask:0xf bank_mask:0xf
    v_add_f32_dpp v29, v29, v29 row_ror:4 row_mask:0xf bank_mask:0xf
    v_add_f32_dpp v30, v30, v30 row_ror:4 row_mask:0xf bank_mask:0xf
    v_add_f32_dpp v32, v32, v32 row_ror:2 row_mask:0xf bank_mask:0xf
    v_add_f32_dpp v33, v33, v33 row_ror:2 row_mask:0xf bank_mask:0xf
    v_add_f32_dpp v34, v34, v34 row_ror:2 row_mask:0xf bank_mask:0xf
    v_add_f32_dpp v35, v35, v35 row_ror:2 row_mask:0xf bank_mask:0xf
    v_add_f32_dpp v36, v36, v36 row_ror:2 row_mask:0xf bank_mask:0xf
    v_add_f32_dpp v37, v37, v37 row_ror:2 row_mask:0xf bank_mask:0xf
    v_add_f32_dpp v38, v38, v38 row_ror:2 row_mask:0xf bank_mask:0xf
    v_add_f32_dpp v39, v39, v39 row_ror:2 row_mask:0xf bank_mask:0xf
    v_add_f32_dpp v40, v40, v40 row_ror:2 row_mask:0xf bank_mask:0xf
    v_add_f32_dpp v41, v41, v41 row_ror:2 row_mask:0xf bank_mask:0xf
    v_add_f32_dpp v42, v42, v42 row_ror:2 row_mask:0xf bank_mask:0xf
    v_add_f32_dpp v43, v43, v43 row_ror:2 row_mask:0xf bank_mask:0xf
    v_add_f32_dpp v44, v44, v44 row_ror:2 row_mask:0xf bank_mask:0xf
    v_add_f32_dpp v45, v45, v45 row_ror:2 row_mask:0xf bank_mask:0xf
    v_add_f32_dpp v46, v46, v46 row_ror:2 row_mask:0xf bank_mask:0xf
    v_add_f32_dpp v47, v47, v47 row_ror:2 row_mask:0xf bank_mask:0xf
    v_add_f32_dpp v28, v28, v28 row_ror:2 row_mask:0xf bank_mask:0xf
    v_add_f32_dpp v29, v29, v29 row_ror:2 row_mask:0xf bank_mask:0xf
    v_add_f32_dpp v30, v30, v30 row_ror:2 row_mask:0xf bank_mask:0xf
    v_add_f32_dpp v32, v32, v32 row_ror:1 row_mask:0xf bank_mask:0xf
    v_add_f32_dpp v33, v33, v33 row_ror:1 row_mask:0xf bank_mask:0xf
    v_add_f32_dpp v34, v34, v34 row_ror:1 row_mask:0xf bank_mask:0xf
    v_add_f32_dpp v35, v35, v35 row_ror:1 row_mask:0xf bank_mask:0xf
    v_add_f32_dpp v36, v36, v36 row_ror:1 row_mask:0xf bank_mask:0xf
    v_add_f32_dpp v37, v37, v37 row_ror:1 row_mask:0xf bank_mask:0xf
    v_add_f32_dpp v38, v38, v38 row_ror:1 row_mask:0xf bank_mask:0xf
    v_add_f32_dpp v39, v39, v39 row_ror:1 row_mask:0xf bank_mask:0xf
    v_add_f32_dpp v40, v40, v40 row_ror:1 row_mask:0xf bank_mask:0xf
    v_add_f32_dpp v41, v41, v41 row_ror:1 row_mask:0xf bank_mask:0xf
    v_add_f32_dpp v42, v42, v42 row_ror:1 row_mask:0xf bank_mask:0xf
    v_add_f32_dpp v43, v43, v43 row_ror:1 row_mask:0xf bank_mask:0xf
    v_add_f32_dpp v44, v44, v44 row_ror:1 row_mask:0xf bank_mask:0xf
    v_add_f32_dpp v45, v45, v45 row_ror:1 row_mask:0xf bank_mask:0xf
    v_add_f32_dpp v46, v46, v46 row_ror:1 row_mask:0xf bank_mask:0xf
    v_add_f32_dpp v47, v47, v47 row_ror:1 row_mask:0xf bank_mask:0xf
    v_add_f32_dpp v28, v28, v28 row_ror:1 row_mask:0xf bank_mask:0xf
    v_add_f32_dpp v29, v29, v29 row_ror:1 row_mask:0xf bank_mask:0xf
    v_add_f32_dpp v30, v30, v30 row_ror:1 row_mask:0xf bank_mask:0xf
    s_nop 1
    v_add_f32_dpp v28, v28, v28 row_bcast:15 row_mask:0xa bank_mask:0xf
    v_add_f32_dpp v29, v29, v29 row_bcast:15 row_mask:0xa bank_mask:0xf
    v_add_f32_dpp v30, v30, v30 row_bcast:15 row_mask:0xa bank_mask:0xf
    s_nop 1
    v_add_f32_dpp v28, v28, v28 row_bcast:31 row_mask:0xc bank_mask:0xf
    v_add_f32_dpp v29, v29, v29 row_bcast:31 row_mask:0xc bank_mask:0xf
    v_add_f32_dpp v30, v30, v30 row_bcast:31 row_mask:0xc bank_mask:0xf
    v_cvt_pk_bf16_f32 v48, v32, v33
    v_cvt_pk_bf16_f32 v49, v34, v35
    v_cvt_pk_bf16_f32 v50, v36, v37
    v_cvt_pk_bf16_f32 v51, v38, v39
    v_cvt_pk_bf16_f32 v52, v40, v41
    v_cvt_pk_bf16_f32 v53, v42, v43
    v_cvt_pk_bf16_f32 v54, v44, v45
    v_cvt_pk_bf16_f32 v55, v46, v47
    v_add_f32 v28, v28, v232
    v_add_f32 v29, v29, v233
    v_add_f32 v30, v30, v234
    v_cvt_pk_bf16_f32 v56, v28, v29
    v_cvt_pk_bf16_f32 v57, v30, v30
    v_lshrrev_b32 v58, 16, v56
    s_lshl_b32 s73, s64, 7
    s_mov_b64 exec, s[78:79]
    buffer_store_dwordx2 v[48:49], v6, s[52:55], s73 offen offset:0
    buffer_store_dwordx2 v[50:51], v6, s[52:55], s73 offen offset:32
    buffer_store_dwordx2 v[52:53], v6, s[52:55], s73 offen offset:64
    buffer_store_dwordx2 v[54:55], v6, s[52:55], s73 offen offset:96
    s_mul_i32 s73, s64, 6
    s_mov_b64 exec, s[80:81]
    buffer_store_short v56, v7, s[56:59], s73 offen
    buffer_store_short v58, v7, s[56:59], s73 offen offset:2
    buffer_store_short v57, v7, s[56:59], s73 offen offset:4
    s_mov_b64 exec, -1
    v_mov_b32 v32, 0
    v_mov_b32 v33, 0
    v_mov_b32 v34, 0
    v_mov_b32 v35, 0
    v_mov_b32 v36, 0
    v_mov_b32 v37, 0
    v_mov_b32 v38, 0
    v_mov_b32 v39, 0
    v_mov_b32 v40, 0
    v_mov_b32 v41, 0
    v_mov_b32 v42, 0
    v_mov_b32 v43, 0
    v_mov_b32 v44, 0
    v_mov_b32 v45, 0
    v_mov_b32 v46, 0
    v_mov_b32 v47, 0
    v_mov_b32 v28, 0
    v_mov_b32 v29, 0
    v_mov_b32 v30, 0
K3_NOFIN5:
    s_branch K3_LOOP
K3_END:
    s_endpgm
.globl egnn_k4_kernel
.p2align 8
.type egnn_k4_kernel,@function
egnn_k4_kernel:
    s_load_dwordx16 s[4:19], s[0:1], 0
    s_load_dwordx2 s[20:21], s[0:1], 64
    s_load_dwordx2 s[22:23], s[0:1], 80
    s_waitcnt lgkmcnt(0)
    s_cmp_ge_u32 s2, 157
    s_cbranch_scc1 K4_END
    s_add_u32 s24, s22, 0xcc4000
    s_addc_u32 s25, s23, 0
    s_mov_b32 s26, 16384
    s_mov_b32 s27, 0x00020000
    s_mov_b32 s28, s4
    s_mov_b32 s29, s5
    s_mov_b32 s30, 1280000
    s_mov_b32 s31, 0x00020000
    s_add_u32 s32, s22, 0x7c0000
    s_addc_u32 s33, s23, 0
    s_mov_b32 s34, 1280000
    s_mov_b32 s35, 0x00020000
    s_mov_b32 s36, s20
    s_mov_b32 s37, s21
    s_mov_b32 s38, 1280000
    s_mov_b32 s39, 0x00020000
    v_and_b32 v1, 63, v0
    v_lshrrev_b32 v2, 6, v0
    v_and_b32 v3, 15, v1
    v_lshrrev_b32 v4, 4, v1
    v_lshlrev_b32 v6, 4, v1
    buffer_load_dwordx4 v[64:67], v6, s[24:27], 0 offen offset:0
    buffer_load_dwordx4 v[68:71], v6, s[24:27], 0 offen offset:1024
    buffer_load_dwordx4 v[72:75], v6, s[24:27], 0 offen offset:2048
    buffer_load_dwordx4 v[76:79], v6, s[24:27], 0 offen offset:3072
    v_add_u32 v7, 4096, v6
    buffer_load_dwordx4 v[80:83], v7, s[24:27], 0 offen
    v_add_u32 v7, 5120, v6
    buffer_load_dwordx4 v[84:87], v7, s[24:27], 0 offen
    v_add_u32 v7, 6144, v6
    buffer_load_dwordx4 v[88:91], v7, s[24:27], 0 offen
    v_add_u32 v7, 7168, v6
    buffer_load_dwordx4 v[92:95], v7, s[24:27], 0 offen
    v_add_u32 v7, 8192, v6
    buffer_load_dwordx4 v[96:99], v7, s[24:27], 0 offen
    v_add_u32 v7, 9216, v6
    buffer_load_dwordx4 v[100:103], v7, s[24:27], 0 offen
    v_add_u32 v7, 10240, v6
    buffer_load_dwordx4 v[104:107], v7, s[24:27], 0 offen
    v_add_u32 v7, 11264, v6
    buffer_load_dwordx4 v[108:111], v7, s[24:27], 0 offen
    v_add_u32 v7, 12288, v6
    buffer_load_dwordx4 v[112:115], v7, s[24:27], 0 offen
    v_add_u32 v7, 13312, v6
    buffer_load_dwordx4 v[116:119], v7, s[24:27], 0 offen
    v_add_u32 v7, 14336, v6
    buffer_load_dwordx4 v[120:123], v7, s[24:27], 0 offen
    v_add_u32 v7, 15360, v6
    buffer_load_dwordx4 v[124:127], v7, s[24:27], 0 offen
    v_lshlrev_b32 v6, 6, s2
    v_lshl_add_u32 v6, v2, 4, v6
    v_add_u32 v6, v6, v3
    v_lshlrev_b32 v7, 7, v6
    v_lshl_add_u32 v8, v4, 4, v7
    buffer_load_dwordx4 v[16:19], v8, s[28:31], 0 offen
    buffer_load_dwordx4 v[20:23], v8, s[28:31], 0 offen offset:64
    buffer_load_dwordx4 v[24:27], v8, s[32:35], 0 offen
    buffer_load_dwordx4 v[28:31], v8, s[32:35], 0 offen offset:64
    v_lshl_add_u32 v9, v4, 3, v7
    buffer_load_dwordx2 v[32:33], v9, s[28:31], 0 offen offset:0
    buffer_load_dwordx2 v[34:35], v9, s[28:31], 0 offen offset:32
    buffer_load_dwordx2 v[36:37], v9, s[28:31], 0 offen offset:64
    buffer_load_dwordx2 v[38:39], v9, s[28:31], 0 offen offset:96
    s_waitcnt vmcnt(0)
    v_mfma_f32_16x16x32_bf16 v[48:51], v[64:67], v[16:19], 0
    v_mfma_f32_16x16x32_bf16 v[48:51], v[80:83], v[20:23], v[48:51]
    v_mfma_f32_16x16x32_bf16 v[48:51], v[96:99], v[24:27], v[48:51]
    v_mfma_f32_16x16x32_bf16 v[48:51], v[112:115], v[28:31], v[48:51]
    v_mfma_f32_16x16x32_bf16 v[52:55], v[68:71], v[16:19], 0
    v_mfma_f32_16x16x32_bf16 v[52:55], v[84:87], v[20:23], v[52:55]
    v_mfma_f32_16x16x32_bf16 v[52:55], v[100:103], v[24:27], v[52:55]
    v_mfma_f32_16x16x32_bf16 v[52:55], v[116:119], v[28:31], v[52:55]
    v_mfma_f32_16x16x32_bf16 v[56:59], v[72:75], v[16:19], 0
    v_mfma_f32_16x16x32_bf16 v[56:59], v[88:91], v[20:23], v[56:59]
    v_mfma_f32_16x16x32_bf16 v[56:59], v[104:107], v[24:27], v[56:59]
    v_mfma_f32_16x16x32_bf16 v[56:59], v[120:123], v[28:31], v[56:59]
    v_mfma_f32_16x16x32_bf16 v[60:63], v[76:79], v[16:19], 0
    v_mfma_f32_16x16x32_bf16 v[60:63], v[92:95], v[20:23], v[60:63]
    v_mfma_f32_16x16x32_bf16 v[60:63], v[108:111], v[24:27], v[60:63]
    v_mfma_f32_16x16x32_bf16 v[60:63], v[124:127], v[28:31], v[60:63]
    s_nop 15
    v_mul_f32 v15, 0xbfb8aa3b, v48
    v_exp_f32 v15, v15
    s_nop 0
    v_add_f32 v15, 1.0, v15
    v_rcp_f32 v15, v15
    s_nop 0
    v_mul_f32 v48, v48, v15
    v_mul_f32 v15, 0xbfb8aa3b, v49
    v_exp_f32 v15, v15
    s_nop 0
    v_add_f32 v15, 1.0, v15
    v_rcp_f32 v15, v15
    s_nop 0
    v_mul_f32 v49, v49, v15
    v_mul_f32 v15, 0xbfb8aa3b, v50
    v_exp_f32 v15, v15
    s_nop 0
    v_add_f32 v15, 1.0, v15
    v_rcp_f32 v15, v15
    s_nop 0
    v_mul_f32 v50, v50, v15
    v_mul_f32 v15, 0xbfb8aa3b, v51
    v_exp_f32 v15, v15
    s_nop 0
    v_add_f32 v15, 1.0, v15
    v_rcp_f32 v15, v15
    s_nop 0
    v_mul_f32 v51, v51, v15
    v_mul_f32 v15, 0xbfb8aa3b, v52
    v_exp_f32 v15, v15
    s_nop 0
    v_add_f32 v15, 1.0, v15
    v_rcp_f32 v15, v15
    s_nop 0
    v_mul_f32 v52, v52, v15
    v_mul_f32 v15, 0xbfb8aa3b, v53
    v_exp_f32 v15, v15
    s_nop 0
    v_add_f32 v15, 1.0, v15
    v_rcp_f32 v15, v15
    s_nop 0
    v_mul_f32 v53, v53, v15
    v_mul_f32 v15, 0xbfb8aa3b, v54
    v_exp_f32 v15, v15
    s_nop 0
    v_add_f32 v15, 1.0, v15
    v_rcp_f32 v15, v15
    s_nop 0
    v_mul_f32 v54, v54, v15
    v_mul_f32 v15, 0xbfb8aa3b, v55
    v_exp_f32 v15, v15
    s_nop 0
    v_add_f32 v15, 1.0, v15
    v_rcp_f32 v15, v15
    s_nop 0
    v_mul_f32 v55, v55, v15
    v_mul_f32 v15, 0xbfb8aa3b, v56
    v_exp_f32 v15, v15
    s_nop 0
    v_add_f32 v15, 1.0, v15
    v_rcp_f32 v15, v15
    s_nop 0
    v_mul_f32 v56, v56, v15
    v_mul_f32 v15, 0xbfb8aa3b, v57
    v_exp_f32 v15, v15
    s_nop 0
    v_add_f32 v15, 1.0, v15
    v_rcp_f32 v15, v15
    s_nop 0
    v_mul_f32 v57, v57, v15
    v_mul_f32 v15, 0xbfb8aa3b, v58
    v_exp_f32 v15, v15
    s_nop 0
    v_add_f32 v15, 1.0, v15
    v_rcp_f32 v15, v15
    s_nop 0
    v_mul_f32 v58, v58, v15
    v_mul_f32 v15, 0xbfb8aa3b, v59
    v_exp_f32 v15, v15
    s_nop 0
    v_add_f32 v15, 1.0, v15
    v_rcp_f32 v15, v15
    s_nop 0
    v_mul_f32 v59, v59, v15
    v_mul_f32 v15, 0xbfb8aa3b, v60
    v_exp_f32 v15, v15
    s_nop 0
    v_add_f32 v15, 1.0, v15
    v_rcp_f32 v15, v15
    s_nop 0
    v_mul_f32 v60, v60, v15
    v_mul_f32 v15, 0xbfb8aa3b, v61
    v_exp_f32 v15, v15
    s_nop 0
    v_add_f32 v15, 1.0, v15
    v_rcp_f32 v15, v15
    s_nop 0
    v_mul_f32 v61, v61, v15
    v_mul_f32 v15, 0xbfb8aa3b, v62
    v_exp_f32 v15, v15
    s_nop 0
    v_add_f32 v15, 1.0, v15
    v_rcp_f32 v15, v15
    s_nop 0
    v_mul_f32 v62, v62, v15
    v_mul_f32 v15, 0xbfb8aa3b, v63
    v_exp_f32 v15, v15
    s_nop 0
    v_add_f32 v15, 1.0, v15
    v_rcp_f32 v15, v15
    s_nop 0
    v_mul_f32 v63, v63, v15
    v_cvt_pk_bf16_f32 v40, v48, v49
    v_cvt_pk_bf16_f32 v41, v50, v51
    v_lshlrev_b32 v42, 16, v40
    v_and_b32 v43, 0xffff0000, v40
    v_lshlrev_b32 v44, 16, v41
    v_and_b32 v45, 0xffff0000, v41
    v_lshlrev_b32 v46, 16, v32
    v_add_f32 v42, v42, v46
    v_and_b32 v46, 0xffff0000, v32
    v_add_f32 v43, v43, v46
    v_lshlrev_b32 v46, 16, v33
    v_add_f32 v44, v44, v46
    v_and_b32 v46, 0xffff0000, v33
    v_add_f32 v45, v45, v46
    v_cvt_pk_bf16_f32 v10, v42, v43
    v_cvt_pk_bf16_f32 v11, v44, v45
    v_cvt_pk_bf16_f32 v40, v52, v53
    v_cvt_pk_bf16_f32 v41, v54, v55
    v_lshlrev_b32 v42, 16, v40
    v_and_b32 v43, 0xffff0000, v40
    v_lshlrev_b32 v44, 16, v41
    v_and_b32 v45, 0xffff0000, v41
    v_lshlrev_b32 v46, 16, v34
    v_add_f32 v42, v42, v46
    v_and_b32 v46, 0xffff0000, v34
    v_add_f32 v43, v43, v46
    v_lshlrev_b32 v46, 16, v35
    v_add_f32 v44, v44, v46
    v_and_b32 v46, 0xffff0000, v35
    v_add_f32 v45, v45, v46
    v_cvt_pk_bf16_f32 v12, v42, v43
    v_cvt_pk_bf16_f32 v13, v44, v45
    v_cvt_pk_bf16_f32 v40, v56, v57
    v_cvt_pk_bf16_f32 v41, v58, v59
    v_lshlrev_b32 v42, 16, v40
    v_and_b32 v43, 0xffff0000, v40
    v_lshlrev_b32 v44, 16, v41
    v_and_b32 v45, 0xffff0000, v41
    v_lshlrev_b32 v46, 16, v36
    v_add_f32 v42, v42, v46
    v_and_b32 v46, 0xffff0000, v36
    v_add_f32 v43, v43, v46
    v_lshlrev_b32 v46, 16, v37
    v_add_f32 v44, v44, v46
    v_and_b32 v46, 0xffff0000, v37
    v_add_f32 v45, v45, v46
    v_cvt_pk_bf16_f32 v14, v42, v43
    v_cvt_pk_bf16_f32 v15, v44, v45
    v_cvt_pk_bf16_f32 v40, v60, v61
    v_cvt_pk_bf16_f32 v41, v62, v63
    v_lshlrev_b32 v42, 16, v40
    v_and_b32 v43, 0xffff0000, v40
    v_lshlrev_b32 v44, 16, v41
    v_and_b32 v45, 0xffff0000, v41
    v_lshlrev_b32 v46, 16, v38
    v_add_f32 v42, v42, v46
    v_and_b32 v46, 0xffff0000, v38
    v_add_f32 v43, v43, v46
    v_lshlrev_b32 v46, 16, v39
    v_add_f32 v44, v44, v46
    v_and_b32 v46, 0xffff0000, v39
    v_add_f32 v45, v45, v46
    v_cvt_pk_bf16_f32 v16, v42, v43
    v_cvt_pk_bf16_f32 v17, v44, v45
    buffer_store_dwordx2 v[10:11], v9, s[36:39], 0 offen offset:0
    buffer_store_dwordx2 v[12:13], v9, s[36:39], 0 offen offset:32
    buffer_store_dwordx2 v[14:15], v9, s[36:39], 0 offen offset:64
    buffer_store_dwordx2 v[16:17], v9, s[36:39], 0 offen offset:96
K4_END:
    s_endpgm
.section .rodata,"a"
.p2align 6
.amdhsa_kernel egnn_k0_kernel
  .amdhsa_next_free_vgpr 76
  .amdhsa_next_free_sgpr 96
  .amdhsa_accum_offset 76
  .amdhsa_group_segment_fixed_size 0
  .amdhsa_kernarg_size 88
  .amdhsa_user_sgpr_count 2
  .amdhsa_user_sgpr_kernarg_segment_ptr 1
  .amdhsa_system_sgpr_workgroup_id_x 1
.end_amdhsa_kernel
.p2align 6
.amdhsa_kernel egnn_k1_kernel
  .amdhsa_next_free_vgpr 52
  .amdhsa_next_free_sgpr 96
  .amdhsa_accum_offset 52
  .amdhsa_group_segment_fixed_size 0
  .amdhsa_kernarg_size 88
  .amdhsa_user_sgpr_count 2
  .amdhsa_user_sgpr_kernarg_segment_ptr 1
  .amdhsa_system_sgpr_workgroup_id_x 1
.end_amdhsa_kernel
.p2align 6
.amdhsa_kernel egnn_k2_kernel
  .amdhsa_next_free_vgpr 80
  .amdhsa_next_free_sgpr 96
  .amdhsa_accum_offset 80
  .amdhsa_group_segment_fixed_size 0
  .amdhsa_kernarg_size 88
  .amdhsa_user_sgpr_count 2
  .amdhsa_user_sgpr_kernarg_segment_ptr 1
  .amdhsa_system_sgpr_workgroup_id_x 1
.end_amdhsa_kernel
.p2align 6
.amdhsa_kernel egnn_k3_kernel
  .amdhsa_next_free_vgpr 256
  .amdhsa_next_free_sgpr 96
  .amdhsa_accum_offset 256
  .amdhsa_group_segment_fixed_size 0
  .amdhsa_kernarg_size 88
  .amdhsa_user_sgpr_count 2
  .amdhsa_user_sgpr_kernarg_segment_ptr 1
  .amdhsa_system_sgpr_workgroup_id_x 1
.end_amdhsa_kernel
.p2align 6
.amdhsa_kernel egnn_k4_kernel
  .amdhsa_next_free_vgpr 128
  .amdhsa_next_free_sgpr 96
  .amdhsa_accum_offset 128
  .amdhsa_group_segment_fixed_size 0
  .amdhsa_kernarg_size 88
  .amdhsa_user_sgpr_count 2
  .amdhsa_user_sgpr_kernarg_segment_ptr 1
  .amdhsa_system_sgpr_workgroup_id_x 1
.end_amdhsa_kernel
```
